```python
import torch

def _softmax(x, axis=-1):
    return torch.softmax(x, dim=axis)

def _gelu(x):
    return torch.nn.functional.gelu(x, approximate='tanh')

def _silu(x):
    return torch.nn.functional.silu(x)

def _sigmoid(x):
    return torch.sigmoid(x)

def _layernorm(x, axis=-1, eps=1e-05):
    m = x.mean(dim=axis, keepdim=True)
    v = x.var(dim=axis, keepdim=True, unbiased=False)
    return (x - m) / torch.sqrt(v + eps)

def _scatter_add(tgt, idx, src, axis=0):
    return tgt.clone().index_add_(axis, idx, src)

def _segment_sum(src, seg, n):
    out = torch.zeros((n,) + src.shape[1:], dtype=src.dtype)
    return out.index_add_(0, seg, src)

def _pad(x, pw):
    flat = tuple((v for pair in reversed(pw) for v in pair))
    return torch.nn.functional.pad(x, flat)
kernel_name = 'standalone__video_video_swin__vision'

def setup_inputs():

    _w = lambda a: (lambda t: t.to(torch.bfloat16) if t.is_floating_point() else t)(torch.as_tensor(a))
    T = 4
    H = W = 384 // 7 * 7
    C, win = (96, 7)
    return {'x': _w((lambda *s: torch.randn(*s, dtype=torch.bfloat16) * 0.1)(1, T, H, W, C)), 'wqkv_t': _w((lambda *s: torch.randn(*s, dtype=torch.bfloat16) * 0.1)(C, 3 * C)), 'wo_t': _w((lambda *s: torch.randn(*s, dtype=torch.bfloat16) * 0.1)(C, C)), 'wqkv_s': _w((lambda *s: torch.randn(*s, dtype=torch.bfloat16) * 0.1)(C, 3 * C)), 'wo_s': _w((lambda *s: torch.randn(*s, dtype=torch.bfloat16) * 0.05)(C, C))}

def reference(x, wqkv_t, wo_t, wqkv_s, wo_s):
    B, T, H, W, C = x.shape
    win = 7
    scale = C ** (-0.5)
    h = _layernorm(x, axis=-1)
    ht = (lambda x, *d: x.permute(*d))(h, 0, 2, 3, 1, 4).reshape(B * H * W, T, C)
    qkv = ht @ wqkv_t
    q, k, v = (qkv[..., :C].clone(), qkv[..., C:2 * C].clone(), qkv[..., 2 * C:].clone())
    p = _softmax(torch.einsum('btc,bsc->bts', q, k) * scale, axis=-1)
    ot = torch.einsum('bts,bsc->btc', p, v) @ wo_t
    ot = (lambda x, *d: x.permute(*d))(ot.reshape(B, H, W, T, C), 0, 3, 1, 2, 4)
    x = x + ot
    h = _layernorm(x, axis=-1)
    nh, nw = (H // win, W // win)
    hs = h.reshape(B * T, nh, win, nw, win, C)
    hw = (lambda x, *d: x.permute(*d))(hs, 0, 1, 3, 2, 4, 5).reshape(B * T * nh * nw, win * win, C)
    qkv = hw @ wqkv_s
    q, k, v = (qkv[..., :C].clone(), qkv[..., C:2 * C].clone(), qkv[..., 2 * C:].clone())
    p = _softmax(torch.einsum('bqc,bkc->bqk', q, k) * scale, axis=-1)
    os = torch.einsum('bqk,bkc->bqc', p, v) @ wo_s
    os = (lambda x, *d: x.permute(*d))(os.reshape(B * T, nh, nw, win, win, C), 0, 1, 3, 2, 4, 5)
    os = os.reshape(B, T, H, W, C)
    return x + os
```

```asm
; @launch grid=(243,1,1) block=(512,1,1) lds=163840
.amdgcn_target "amdgcn-amd-amdhsa--gfx950"
.text
.globl standalone__video_video_swin__vision_kernel
.p2align 8
.type standalone__video_video_swin__vision_kernel,@function
standalone__video_video_swin__vision_kernel:
    s_cmp_ge_u32 s2, 0xf3
    s_cbranch_scc1 L_end
    s_load_dwordx16 s[20:35], s[0:1], 0
    v_lshrrev_b32 v1, 6, v0
    s_mov_b32 s92, -1
    v_readfirstlane_b32 s36, v1
    s_mov_b32 s93, 0
    s_and_b32 s37, s36, 3
    s_cmp_lt_u32 s37, 3
    s_cselect_b32 s90, 3, 0
    s_cselect_b32 s56, s37, 0
    s_mul_i32 s67, s56, 0x4800
    s_cmp_lt_u32 s36, 4
    s_cselect_b32 s62, 0, 0x12000
    v_and_b32 v106, 63, v0
    s_and_b32 s56, s90, 0
    v_xor_b32 v100, s56, v106
    s_and_b32 s56, s90, 3
    v_lshlrev_b32 v100, 4, v100
    v_xor_b32 v101, s56, v106
    s_and_b32 s56, s90, 2
    v_lshlrev_b32 v101, 4, v101
    v_xor_b32 v102, s56, v106
    s_and_b32 s56, s90, 1
    v_lshlrev_b32 v102, 4, v102
    v_xor_b32 v103, s56, v106
    v_cndmask_b32_e64 v104, v101, v100, s[92:93]
    v_lshlrev_b32 v103, 4, v103
    v_cndmask_b32_e64 v105, v103, v102, s[92:93]
    s_waitcnt lgkmcnt(0)
    s_cmp_lt_u32 s36, 4
    s_cselect_b32 s12, s22, s26
    s_cselect_b32 s13, s23, s27
    s_cselect_b32 s16, s24, s28
    s_cselect_b32 s17, s25, s29
    s_mov_b32 s56, 0x4800
    s_cmp_lt_u32 s37, 3
    s_cselect_b32 s12, s12, s16
    s_cselect_b32 s13, s13, s17
    s_cselect_b32 s14, 0xd800, s56
    s_mov_b32 s15, 0x20000
    s_cmp_ge_u32 s36, 4
    s_cbranch_scc1 L_nodma
    s_mul_i32 s56, s37, 0x4800
    s_add_u32 s56, s56, s62
    s_add_u32 m0, s56, 0
    s_add_u32 s57, s67, 0
    buffer_load_dwordx4 v100, s[12:15], s57 offen lds
    s_add_u32 m0, s56, 0x400
    s_add_u32 s57, s67, 0x400
    buffer_load_dwordx4 v100, s[12:15], s57 offen lds
    s_add_u32 m0, s56, 0x800
    s_add_u32 s57, s67, 0x800
    buffer_load_dwordx4 v100, s[12:15], s57 offen lds
    s_add_u32 m0, s56, 0xc00
    s_add_u32 s57, s67, 0xc00
    buffer_load_dwordx4 v100, s[12:15], s57 offen lds
    s_add_u32 m0, s56, 0x1000
    s_add_u32 s57, s67, 0x1000
    buffer_load_dwordx4 v104, s[12:15], s57 offen lds
    s_add_u32 m0, s56, 0x1400
    s_add_u32 s57, s67, 0x1400
    buffer_load_dwordx4 v101, s[12:15], s57 offen lds
    s_add_u32 m0, s56, 0x1800
    s_add_u32 s57, s67, 0x1800
    buffer_load_dwordx4 v101, s[12:15], s57 offen lds
    s_add_u32 m0, s56, 0x1c00
    s_add_u32 s57, s67, 0x1c00
    buffer_load_dwordx4 v101, s[12:15], s57 offen lds
    s_add_u32 m0, s56, 0x2000
    s_add_u32 s57, s67, 0x2000
    buffer_load_dwordx4 v101, s[12:15], s57 offen lds
    s_add_u32 m0, s56, 0x2400
    s_add_u32 s57, s67, 0x2400
    buffer_load_dwordx4 v102, s[12:15], s57 offen lds
    s_add_u32 m0, s56, 0x2800
    s_add_u32 s57, s67, 0x2800
    buffer_load_dwordx4 v102, s[12:15], s57 offen lds
    s_add_u32 m0, s56, 0x2c00
    s_add_u32 s57, s67, 0x2c00
    buffer_load_dwordx4 v102, s[12:15], s57 offen lds
    s_add_u32 m0, s56, 0x3000
    s_add_u32 s57, s67, 0x3000
    buffer_load_dwordx4 v102, s[12:15], s57 offen lds
    s_add_u32 m0, s56, 0x3400
    s_add_u32 s57, s67, 0x3400
    buffer_load_dwordx4 v105, s[12:15], s57 offen lds
    s_add_u32 m0, s56, 0x3800
    s_add_u32 s57, s67, 0x3800
    buffer_load_dwordx4 v103, s[12:15], s57 offen lds
    s_add_u32 m0, s56, 0x3c00
    s_add_u32 s57, s67, 0x3c00
    buffer_load_dwordx4 v103, s[12:15], s57 offen lds
    s_add_u32 m0, s56, 0x4000
    s_add_u32 s57, s67, 0x4000
    buffer_load_dwordx4 v103, s[12:15], s57 offen lds
    s_add_u32 m0, s56, 0x4400
    s_add_u32 s57, s67, 0x4400
    buffer_load_dwordx4 v103, s[12:15], s57 offen lds
L_nodma:
    s_mov_b32 s40, s2
    s_mov_b32 s41, 0xf3
    s_cmp_lt_u32 s2, 0
    s_cselect_b32 s38, 13, 12
    s_mov_b32 s39, 0
    s_mul_i32 s54, s37, 0x1a29b00
    s_mov_b32 s55, 0x12000
    s_mov_b32 s42, 0xf0000f
    s_mov_b32 s43, 0xf0000f00
    s_mov_b32 s44, 0xfff0fff
    s_mov_b32 s45, 0xfff0fff
    s_mov_b32 s46, 0x22222222
    s_mov_b32 s47, 0x22222222
    s_mov_b32 s48, 0x44444444
    s_mov_b32 s49, 0x44444444
    s_mov_b32 s50, 0x88888888
    s_mov_b32 s51, 0x88888888
    s_mov_b32 s52, 0xffffffff
    s_mov_b32 s53, 0x1111ffff
    s_mov_b32 s4, s20
    s_mov_b32 s5, s21
    s_mov_b32 s6, 0x68a6c00
    s_mov_b32 s7, 0x20000
    s_mov_b32 s8, s30
    s_mov_b32 s9, s31
    s_mov_b32 s10, 0x68a6c00
    s_mov_b32 s11, 0x20000
    s_and_b32 s56, s36, 1
    s_mul_i32 s63, s56, 3
    s_mov_b32 s66, 0x9000
    s_add_u32 s57, s36, 2
    s_and_b32 s57, s57, 4
    s_cmp_eq_u32 s57, 0
    s_cselect_b32 s64, -1, 0
    s_cselect_b32 s65, -1, 0
    s_cselect_b32 s68, 0x900, 8
    s_cselect_b32 s57, 0, 0x4800
    s_add_u32 s66, s66, s57
    s_mul_i32 s56, s56, 0x2400
    s_add_u32 s66, s66, s56
    v_and_b32 v62, 63, v0
    s_add_u32 s56, s62, 0xd800
    v_and_b32 v60, 3, v62
    v_lshrrev_b32 v61, 2, v62
    v_lshrrev_b32 v72, 4, v62
    v_and_b32 v61, 3, v61
    s_add_u32 s58, s63, 0
    v_lshl_add_u32 v56, v61, 3, v60
    v_sub_u32 v73, 0, v61
    v_mul_u32_u24 v56, 0x240, v56
    v_xor_b32 v73, v73, v72
    v_lshl_add_u32 v61, v72, 3, v61
    v_and_b32 v73, 3, v73
    v_mul_u32_u24 v57, 0x240, v61
    v_lshl_add_u32 v56, v73, 4, v56
    v_sub_u32 v73, 0, v72
    v_add_u32 v56, s62, v56
    v_xor_b32 v73, v73, v60
    v_mov_b32 v68, 0x3f803f80
    v_and_b32 v73, 3, v73
    v_mov_b32 v69, 0x3f803f80
    v_lshl_add_u32 v57, v73, 4, v57
    v_mul_u32_u24 v73, 0xc0, v61
    v_add_u32 v57, s62, v57
    v_lshl_add_u32 v73, v60, 4, v73
    v_mov_b32 v70, 0x3f803f80
    v_add_u32 v73, s56, v73
    s_lshr_b32 s56, s58, 1
    v_cndmask_b32_e64 v73, v73, v56, s[64:65]
    s_lshl_b32 s56, s56, 3
    s_and_b32 s57, s58, 1
    s_add_u32 s56, s56, s57
    s_mul_i32 s56, s56, s68
    v_add_u32 v59, s56, v73
    s_add_u32 s58, s63, 1
    s_lshr_b32 s56, s58, 1
    s_lshl_b32 s56, s56, 3
    s_and_b32 s57, s58, 1
    s_add_u32 s56, s56, s57
    s_mul_i32 s56, s56, s68
    v_add_u32 v58, s56, v73
    s_add_u32 s58, s63, 2
    s_lshr_b32 s56, s58, 1
    s_lshl_b32 s56, s56, 3
    s_and_b32 s57, s58, 1
    s_add_u32 s56, s56, s57
    s_mul_i32 s56, s56, s68
    v_add_u32 v60, s56, v73
    v_mov_b32 v71, 0x3f803f80
    v_and_b32 v61, 1, v62
    v_mov_b32 v64, 0x3f80
    v_lshlrev_b32 v61, 4, v61
    v_and_b32 v65, 2, v62
    v_lshlrev_b32 v61, v61, v64
    v_cmp_eq_u32_e64 s[70:71], 0, v65
    s_cmp_ge_u32 s36, 4
    s_nop 0
    v_cndmask_b32_e64 v64, 0, v61, s[70:71]
    v_cndmask_b32_e64 v65, v61, 0, s[70:71]
    s_nop 0
    s_cbranch_scc1 L_Sinit
    v_and_b32 v91, 63, v0
    s_lshl_b32 s56, s37, 13
    v_lshlrev_b32 v91, 7, v91
    v_add_u32 v92, s56, v91
    s_getpc_b64 s[80:81]
L_pc:
    s_mov_b32 s82, L_end-L_pc
    v_min_u32 v92, s82, v92
    s_nop 0
    global_load_dword v55, v92, s[80:81]
    s_nop 0
    v_and_b32 v74, 63, v0
    s_mul_i32 s56, s37, 3
    v_lshrrev_b32 v75, 4, v74
    v_and_b32 v76, 15, v74
    s_add_u32 s56, s56, 0
    v_and_b32 v77, 3, v76
    v_lshrrev_b32 v78, 2, v76
    s_sub_u32 s57, 0, s56
    s_and_b32 s57, s57, 3
    v_lshrrev_b32 v79, 1, v78
    v_mul_u32_u24 v1, 0x2400, v77
    v_xor_b32 v79, v79, v75
    s_mul_i32 s56, s56, 0x300
    v_xor_b32 v79, v79, v77
    v_mul_u32_u24 v2, 0x2400, v77
    v_xor_b32 v79, s57, v79
    v_mul_u32_u24 v3, 0x2400, v77
    v_lshl_add_u32 v1, v79, 4, v1
    v_mul_u32_u24 v79, 0xc0, v78
    v_lshlrev_b32 v4, 4, v76
    v_add3_u32 v1, v1, v79, s56
    s_mul_i32 s56, s37, 3
    s_add_u32 s56, s56, 1
    s_sub_u32 s57, 0, s56
    s_and_b32 s57, s57, 3
    v_lshrrev_b32 v79, 1, v78
    s_mul_i32 s56, s56, 0x300
    v_xor_b32 v79, v79, v75
    v_lshlrev_b32 v7, 3, v74
    v_xor_b32 v79, v79, v77
    v_lshlrev_b32 v8, 3, v76
    v_xor_b32 v79, s57, v79
    v_mov_b32 v9, 0
    v_lshl_add_u32 v2, v79, 4, v2
    v_mul_u32_u24 v79, 0xc0, v78
    v_mov_b32 v14, 0
    v_add3_u32 v2, v2, v79, s56
    s_mul_i32 s56, s37, 3
    s_add_u32 s56, s56, 2
    s_sub_u32 s57, 0, s56
    s_and_b32 s57, s57, 3
    v_lshrrev_b32 v79, 1, v78
    s_mul_i32 s56, s56, 0x300
    v_xor_b32 v79, v79, v75
    v_mov_b32 v15, 0
    v_xor_b32 v79, v79, v77
    v_mov_b32 v34, 0
    v_xor_b32 v79, s57, v79
    v_mov_b32 v35, 0
    v_lshl_add_u32 v3, v79, 4, v3
    v_mul_u32_u24 v79, 0xc0, v78
    v_mov_b32 v20, 0
    v_add3_u32 v3, v3, v79, s56
    s_mul_i32 s56, s37, 0x700
    s_add_u32 s56, s56, 0x26400
    v_add_u32 v4, s56, v4
    v_min_u32 v79, 47, v74
    v_add_u32 v7, s56, v7
    v_lshlrev_b32 v5, 4, v79
    v_and_b32 v6, 3, v79
    v_add_u32 v5, s56, v5
    v_add_u32 v7, 0x300, v7
    v_lshl_add_u32 v6, v6, 2, v5
    v_add_u32 v8, s56, v8
    v_add_u32 v6, 0x300, v6
    v_add_u32 v8, 0x300, v8
    v_mov_b32 v21, 0
    v_mov_b32 v40, 0
    v_mov_b32 v41, 0
    v_mov_b32 v26, 0
    v_mov_b32 v27, 0
    v_mov_b32 v46, 0
    v_mov_b32 v47, 0
    v_mov_b32 v32, 0
    v_mov_b32 v33, 0
    v_mov_b32 v52, 0
    v_mov_b32 v53, 0
    v_mov_b32 v10, 0x3f803f80
    v_mov_b32 v11, 0x3f803f80
    v_mov_b32 v12, 0x3f803f80
    v_mov_b32 v13, 0x3f803f80
    s_mul_i32 s56, s37, 3
    v_add_u32 v80, s56, v78
    v_mul_u32_u24 v54, 12, v77
    v_mul_u32_u24 v81, s41, v80
    v_add_u32 v54, v54, v80
    v_add_u32 v81, s40, v81
    v_mul_u32_u24 v54, 0xc0, v54
    v_mul_u32_u24 v82, 0x4bdb, v81
    v_lshl_add_u32 v54, v75, 4, v54
    v_lshrrev_b32 v82, 20, v82
    v_add_u32 v54, 0x24000, v54
    v_mul_u32_u24 v79, 54, v82
    v_mul_u32_u24 v82, 0x7c080, v82
    v_sub_u32 v81, v81, v79
    v_cmp_lt_u32_e64 s[70:71], v80, s38
    v_mul_u32_u24 v81, 0x540, v81
    v_add_u32 v81, v81, v82
    v_mul_u32_u24 v82, 0x34536, v77
    v_lshl_add_u32 v81, v82, 7, v81
    v_mov_b32 v82, 0x68a6c00
    v_lshl_add_u32 v81, v75, 4, v81
    v_add_u32 v81, 0x6a980, v81
    v_cndmask_b32_e64 v81, v82, v81, s[70:71]
    v_cndmask_b32_e64 v81, v82, v81, s[44:45]
    buffer_load_dwordx4 v[16:19], v81, s[4:7], 0 offen
    buffer_load_dwordx4 v[22:25], v81, s[4:7], 0 offen offset:64
    buffer_load_dwordx4 v[28:31], v81, s[4:7], 0 offen offset:128
    s_waitcnt vmcnt(4)
    s_barrier
    s_branch L_go
L_Sinit:
    v_and_b32 v32, 63, v0
    v_lshrrev_b32 v33, 4, v32
    v_and_b32 v34, 15, v32
    v_add_u32 v35, 0, v32
    v_mul_u32_u24 v36, 0x1556, v35
    v_lshrrev_b32 v36, 16, v36
    v_lshrrev_b32 v37, 2, v36
    v_lshrrev_b32 v38, 1, v36
    v_sub_u32 v37, 0, v37
    v_and_b32 v38, 1, v38
    v_xor_b32 v37, v37, v38
    v_xor_b32 v37, s37, v37
    v_and_b32 v37, 3, v37
    v_xor_b32 v35, v35, v37
    v_add_u32 v37, 0, v36
    v_lshlrev_b32 v35, 4, v35
    v_mul_u32_u24 v37, 0x2493, v37
    v_lshrrev_b32 v37, 16, v37
    v_mul_u32_u24 v37, 0x11640, v37
    v_add_u32 v37, 0, v37
    v_add_u32 v1, v35, v37
    v_add_u32 v37, 16, v36
    v_mul_u32_u24 v37, 0x2493, v37
    v_lshrrev_b32 v37, 16, v37
    v_mul_u32_u24 v37, 0x11640, v37
    v_add_u32 v37, 0xc00, v37
    v_add_u32 v4, v35, v37
    v_add_u32 v37, 32, v36
    v_mul_u32_u24 v37, 0x2493, v37
    v_lshrrev_b32 v37, 16, v37
    v_mul_u32_u24 v37, 0x11640, v37
    v_add_u32 v37, 0x1800, v37
    v_add_u32 v7, v35, v37
    v_add_u32 v35, 64, v32
    v_mul_u32_u24 v36, 0x1556, v35
    v_lshrrev_b32 v36, 16, v36
    v_lshrrev_b32 v37, 2, v36
    v_lshrrev_b32 v38, 1, v36
    v_sub_u32 v37, 0, v37
    v_and_b32 v38, 1, v38
    v_xor_b32 v37, v37, v38
    v_xor_b32 v37, s37, v37
    v_and_b32 v37, 3, v37
    v_xor_b32 v35, v35, v37
    v_add_u32 v37, 0, v36
    v_lshlrev_b32 v35, 4, v35
    v_mul_u32_u24 v37, 0x2493, v37
    v_lshrrev_b32 v37, 16, v37
    v_mul_u32_u24 v37, 0x11640, v37
    v_add_u32 v37, 0, v37
    v_add_u32 v2, v35, v37
    v_add_u32 v37, 16, v36
    v_mul_u32_u24 v37, 0x2493, v37
    v_lshrrev_b32 v37, 16, v37
    v_mul_u32_u24 v37, 0x11640, v37
    v_add_u32 v37, 0xc00, v37
    v_add_u32 v5, v35, v37
    v_add_u32 v37, 32, v36
    v_mul_u32_u24 v37, 0x2493, v37
    v_lshrrev_b32 v37, 16, v37
    v_mul_u32_u24 v37, 0x11640, v37
    v_add_u32 v37, 0x1800, v37
    v_add_u32 v8, v35, v37
    v_add_u32 v35, 0x80, v32
    s_mul_i32 s61, s37, 0x2400
    v_mul_u32_u24 v36, 0x1556, v35
    s_mul_i32 s56, s37, 0xc00
    v_lshrrev_b32 v36, 16, v36
    s_add_u32 s56, s56, 0x1f800
    v_lshrrev_b32 v37, 2, v36
    v_lshrrev_b32 v38, 1, v36
    v_sub_u32 v37, 0, v37
    v_and_b32 v38, 1, v38
    v_xor_b32 v37, v37, v38
    v_lshrrev_b32 v38, 1, v34
    v_xor_b32 v37, s37, v37
    v_and_b32 v38, 1, v38
    v_and_b32 v37, 3, v37
    v_xor_b32 v35, v35, v37
    v_add_u32 v37, 0, v36
    v_lshlrev_b32 v35, 4, v35
    v_mul_u32_u24 v37, 0x2493, v37
    v_lshrrev_b32 v37, 16, v37
    v_mul_u32_u24 v37, 0x11640, v37
    v_add_u32 v37, 0, v37
    v_add_u32 v3, v35, v37
    v_add_u32 v37, 16, v36
    v_mul_u32_u24 v37, 0x2493, v37
    v_lshrrev_b32 v37, 16, v37
    v_mul_u32_u24 v37, 0x11640, v37
    v_add_u32 v37, 0xc00, v37
    v_add_u32 v6, v35, v37
    v_add_u32 v37, 32, v36
    v_mul_u32_u24 v37, 0x2493, v37
    v_lshrrev_b32 v37, 16, v37
    v_mul_u32_u24 v37, 0x11640, v37
    v_add_u32 v37, 0x1800, v37
    v_add_u32 v9, v35, v37
    v_lshrrev_b32 v37, 2, v34
    v_sub_u32 v37, 0, v37
    v_xor_b32 v37, v37, v38
    v_mul_u32_u24 v38, 0xc0, v34
    v_xor_b32 v37, s37, v37
    v_xor_b32 v37, v37, v33
    v_and_b32 v37, 3, v37
    v_lshl_add_u32 v38, v37, 4, v38
    v_and_b32 v37, 1, v32
    v_add_u32 v10, s61, v38
    v_add_u32 v21, s56, v38
    v_lshlrev_b32 v38, 4, v32
    v_cmp_eq_u32_e64 s[70:71], 0, v37
    v_add_u32 v22, s56, v38
    v_add_u32 v11, 0x9000, v38
    s_mul_i32 s56, s37, 0x900
    v_lshlrev_b32 v38, 4, v33
    s_add_u32 s57, s56, 0x24000
    v_add_u32 v13, s57, v38
    s_add_u32 s57, s56, 0x1b000
    v_add_u32 v35, s57, v38
    s_lshl_b32 s57, s37, 4
    s_add_u32 s57, s57, 0x23c00
    v_mov_b32 v36, s57
    s_add_u32 s57, s56, 0x1d400
    v_cndmask_b32_e64 v12, v36, v35, s[70:71]
    v_mov_b32 v36, 0xc0
    v_lshrrev_b32 v35, 2, v34
    v_cndmask_b32_e64 v25, 0, v36, s[70:71]
    v_and_b32 v36, 3, v34
    s_mul_i32 s56, s37, 0x500
    v_lshl_add_u32 v35, v35, 3, v36
    s_add_u32 s56, s56, 0x22800
    v_lshlrev_b32 v35, 1, v35
    v_and_b32 v36, 3, v32
    v_add_u32 v14, s57, v35
    v_lshlrev_b32 v35, 4, v34
    s_lshl_b32 s57, s37, 6
    v_add_u32 v15, s56, v35
    v_lshlrev_b32 v35, 4, v32
    s_add_u32 s57, s57, 0x23d00
    v_lshl_add_u32 v35, v36, 2, v35
    v_mov_b32 v36, s57
    v_add_u32 v35, s56, v35
    v_cmp_gt_u32_e64 s[70:71], 48, v32
    s_add_u32 s57, s56, 0x300
    v_mov_b32 v27, 0
    v_cndmask_b32_e64 v16, v36, v35, s[70:71]
    v_cndmask_b32_e64 v26, 4, 0, s[70:71]
    v_mov_b32 v36, 0x3e800000
    v_lshlrev_b32 v35, 2, v32
    v_cndmask_b32_e64 v24, v36, 1.0, s[70:71]
    v_add_u32 v17, s57, v35
    v_lshlrev_b32 v35, 4, v33
    v_lshrrev_b32 v36, 2, v34
    v_add_u32 v19, s57, v35
    v_lshlrev_b32 v35, 2, v34
    v_cmp_eq_u32_e64 s[70:71], 0, v34
    v_add_u32 v20, s57, v35
    v_lshrrev_b32 v35, 1, v33
    s_add_u32 s57, s56, 0x400
    v_lshlrev_b32 v35, 5, v35
    v_and_b32 v37, 1, v32
    v_lshl_add_u32 v35, v36, 3, v35
    v_and_b32 v36, 1, v33
    v_lshlrev_b32 v37, 4, v37
    v_lshl_add_u32 v35, v36, 2, v35
    v_and_b32 v36, 3, v34
    v_mov_b32 v28, 0x3f80
    v_add_u32 v35, v35, v36
    v_mov_b32 v36, 0x40000000
    v_lshlrev_b32 v35, 1, v35
    v_lshlrev_b32 v37, v37, v28
    v_add_u32 v18, s57, v35
    v_lshlrev_b32 v35, 4, v33
    v_and_b32 v29, 2, v32
    v_add_u32 v35, 0x6a980, v35
    v_cndmask_b32_e64 v23, v36, v35, s[70:71]
    v_cmp_eq_u32_e64 s[70:71], 0, v29
    s_nop 1
    v_cndmask_b32_e64 v28, 0, v37, s[70:71]
    v_cndmask_b32_e64 v29, v37, 0, s[70:71]
    s_barrier
    s_mul_i32 s56, s37, 0x4800
    s_add_u32 s56, s56, s62
    s_add_u32 m0, s56, 0
    s_add_u32 s57, s67, 0
    buffer_load_dwordx4 v100, s[12:15], s57 offen lds
    s_add_u32 m0, s56, 0x400
    s_add_u32 s57, s67, 0x400
    buffer_load_dwordx4 v100, s[12:15], s57 offen lds
    s_add_u32 m0, s56, 0x800
    s_add_u32 s57, s67, 0x800
    buffer_load_dwordx4 v100, s[12:15], s57 offen lds
    s_add_u32 m0, s56, 0xc00
    s_add_u32 s57, s67, 0xc00
    buffer_load_dwordx4 v100, s[12:15], s57 offen lds
    s_add_u32 m0, s56, 0x1000
    s_add_u32 s57, s67, 0x1000
    buffer_load_dwordx4 v104, s[12:15], s57 offen lds
    s_add_u32 m0, s56, 0x1400
    s_add_u32 s57, s67, 0x1400
    buffer_load_dwordx4 v101, s[12:15], s57 offen lds
    s_add_u32 m0, s56, 0x1800
    s_add_u32 s57, s67, 0x1800
    buffer_load_dwordx4 v101, s[12:15], s57 offen lds
    s_add_u32 m0, s56, 0x1c00
    s_add_u32 s57, s67, 0x1c00
    buffer_load_dwordx4 v101, s[12:15], s57 offen lds
    s_add_u32 m0, s56, 0x2000
    s_add_u32 s57, s67, 0x2000
    buffer_load_dwordx4 v101, s[12:15], s57 offen lds
    s_add_u32 m0, s56, 0x2400
    s_add_u32 s57, s67, 0x2400
    buffer_load_dwordx4 v102, s[12:15], s57 offen lds
    s_add_u32 m0, s56, 0x2800
    s_add_u32 s57, s67, 0x2800
    buffer_load_dwordx4 v102, s[12:15], s57 offen lds
    s_add_u32 m0, s56, 0x2c00
    s_add_u32 s57, s67, 0x2c00
    buffer_load_dwordx4 v102, s[12:15], s57 offen lds
    s_add_u32 m0, s56, 0x3000
    s_add_u32 s57, s67, 0x3000
    buffer_load_dwordx4 v102, s[12:15], s57 offen lds
    s_add_u32 m0, s56, 0x3400
    s_add_u32 s57, s67, 0x3400
    buffer_load_dwordx4 v105, s[12:15], s57 offen lds
    s_add_u32 m0, s56, 0x3800
    s_add_u32 s57, s67, 0x3800
    buffer_load_dwordx4 v103, s[12:15], s57 offen lds
    s_add_u32 m0, s56, 0x3c00
    s_add_u32 s57, s67, 0x3c00
    buffer_load_dwordx4 v103, s[12:15], s57 offen lds
    s_add_u32 m0, s56, 0x4000
    s_add_u32 s57, s67, 0x4000
    buffer_load_dwordx4 v103, s[12:15], s57 offen lds
    s_add_u32 m0, s56, 0x4400
    s_add_u32 s57, s67, 0x4400
    buffer_load_dwordx4 v103, s[12:15], s57 offen lds
    s_waitcnt vmcnt(0)
    s_barrier
    s_add_u32 s58, s39, 0
    s_mul_i32 s69, s58, s41
    s_add_u32 s69, s69, s40
    s_mul_hi_u32 s56, s69, 0x4bda130
    s_mul_i32 s57, s56, 54
    s_sub_u32 s57, s69, s57
    s_mul_i32 s56, s56, 0x7c080
    s_mul_i32 s57, s57, 0x540
    s_add_u32 s59, s56, s57
    s_add_u32 s59, s59, s54
    s_cmp_lt_u32 s58, s38
    s_cselect_b32 s59, s59, 0x68a6c00
    s_add_u32 m0, s61, 0
    s_nop 0
    buffer_load_dwordx4 v1, s[4:7], s59 offen lds
    s_add_u32 m0, s61, 0x400
    s_nop 0
    buffer_load_dwordx4 v2, s[4:7], s59 offen lds
    s_add_u32 m0, s61, 0x800
    s_nop 0
    buffer_load_dwordx4 v3, s[4:7], s59 offen lds
    s_add_u32 m0, s61, 0xc00
    s_nop 0
    buffer_load_dwordx4 v4, s[4:7], s59 offen lds
    s_add_u32 m0, s61, 0x1000
    s_nop 0
    buffer_load_dwordx4 v5, s[4:7], s59 offen lds
    s_add_u32 m0, s61, 0x1400
    s_nop 0
    buffer_load_dwordx4 v6, s[4:7], s59 offen lds
    s_add_u32 m0, s61, 0x1800
    s_nop 0
    buffer_load_dwordx4 v7, s[4:7], s59 offen lds
    s_add_u32 m0, s61, 0x1c00
    s_nop 0
    buffer_load_dwordx4 v8, s[4:7], s59 offen lds
    s_add_u32 m0, s61, 0x2000
    s_nop 0
    buffer_load_dwordx4 v9, s[4:7], s59 offen lds
    s_barrier
    s_setprio 2
L_go:
    s_cmp_eq_u32 s64, 0
    s_cbranch_scc1 L_fuseB
    ds_read_b64_tr_b16 v[152:153], v57 offset:192
    ds_read_b64_tr_b16 v[154:155], v57 offset:2496
    ds_read_b64_tr_b16 v[156:157], v57 offset:18624
    ds_read_b64_tr_b16 v[158:159], v57 offset:20928
    ds_read_b64_tr_b16 v[160:161], v57 offset:37056
    ds_read_b64_tr_b16 v[162:163], v57 offset:39360
    ds_read_b64_tr_b16 v[164:165], v57 offset:200
    ds_read_b64_tr_b16 v[166:167], v57 offset:2504
    ds_read_b64_tr_b16 v[168:169], v57 offset:18632
    ds_read_b64_tr_b16 v[170:171], v57 offset:20936
    ds_read_b64_tr_b16 v[172:173], v57 offset:37064
    ds_read_b64_tr_b16 v[174:175], v57 offset:39368
    ds_read_b64_tr_b16 v[176:177], v57 offset:256
    ds_read_b64_tr_b16 v[178:179], v57 offset:2560
    ds_read_b64_tr_b16 v[180:181], v57 offset:18688
    ds_read_b64_tr_b16 v[182:183], v57 offset:20992
    ds_read_b64_tr_b16 v[184:185], v57 offset:37120
    ds_read_b64_tr_b16 v[186:187], v57 offset:39424
    s_waitcnt lgkmcnt(15)
    v_mfma_f32_16x16x32_bf16 v[188:191], v[152:155], v[68:71], 0
    ds_read_b64_tr_b16 v[152:153], v57 offset:264
    ds_read_b64_tr_b16 v[154:155], v57 offset:2568
    s_waitcnt lgkmcnt(15)
    v_mfma_f32_16x16x32_bf16 v[188:191], v[156:159], v[68:71], v[188:191]
    ds_read_b64_tr_b16 v[156:157], v57 offset:18696
    ds_read_b64_tr_b16 v[158:159], v57 offset:21000
    s_waitcnt lgkmcnt(15)
    v_mfma_f32_16x16x32_bf16 v[188:191], v[160:163], v[68:71], v[188:191]
    ds_read_b64_tr_b16 v[160:161], v57 offset:37128
    ds_read_b64_tr_b16 v[162:163], v57 offset:39432
    s_waitcnt lgkmcnt(15)
    v_mfma_f32_16x16x32_bf16 v[192:195], v[164:167], v[68:71], 0
    s_waitcnt lgkmcnt(14)
    v_mfma_f32_16x16x32_bf16 v[192:195], v[168:171], v[68:71], v[192:195]
    v_mul_f32 v188, 0xbc2aaaab, v188
    v_mul_f32 v189, 0xbc2aaaab, v189
    s_waitcnt lgkmcnt(12)
    v_mfma_f32_16x16x32_bf16 v[192:195], v[172:175], v[68:71], v[192:195]
    v_mul_f32 v190, 0xbc2aaaab, v190
    v_mul_f32 v191, 0xbc2aaaab, v191
    s_waitcnt lgkmcnt(10)
    v_mfma_f32_16x16x32_bf16 v[196:199], v[176:179], v[68:71], 0
    ds_read_b64_tr_b16 v[164:165], v57 offset:320
    ds_read_b64_tr_b16 v[166:167], v57 offset:2624
    s_waitcnt lgkmcnt(10)
    v_mfma_f32_16x16x32_bf16 v[196:199], v[180:183], v[68:71], v[196:199]
    ds_read_b64_tr_b16 v[168:169], v57 offset:18752
    ds_read_b64_tr_b16 v[170:171], v57 offset:21056
    s_waitcnt lgkmcnt(10)
    v_mfma_f32_16x16x32_bf16 v[196:199], v[184:187], v[68:71], v[196:199]
    ds_read_b64_tr_b16 v[172:173], v57 offset:37184
    ds_read_b64_tr_b16 v[174:175], v57 offset:39488
    s_waitcnt lgkmcnt(10)
    v_mfma_f32_16x16x32_bf16 v[200:203], v[152:155], v[68:71], 0
    v_mul_f32 v192, 0xbc2aaaab, v192
    v_mul_f32 v193, 0xbc2aaaab, v193
    s_waitcnt lgkmcnt(8)
    v_mfma_f32_16x16x32_bf16 v[200:203], v[156:159], v[68:71], v[200:203]
    v_mul_f32 v194, 0xbc2aaaab, v194
    v_mul_f32 v195, 0xbc2aaaab, v195
    s_waitcnt lgkmcnt(6)
    v_mfma_f32_16x16x32_bf16 v[200:203], v[160:163], v[68:71], v[200:203]
    ds_read_b64_tr_b16 v[176:177], v57 offset:328
    ds_read_b64_tr_b16 v[178:179], v57 offset:2632
    ds_read_b64_tr_b16 v[180:181], v57 offset:18760
    ds_read_b64_tr_b16 v[182:183], v57 offset:21064
    ds_read_b64_tr_b16 v[184:185], v57 offset:37192
    ds_read_b64_tr_b16 v[186:187], v57 offset:39496
    v_mul_f32 v196, 0xbc2aaaab, v196
    v_mul_f32 v197, 0xbc2aaaab, v197
    v_mul_f32 v198, 0xbc2aaaab, v198
    v_mul_f32 v199, 0xbc2aaaab, v199
    v_mul_f32 v200, 0xbc2aaaab, v200
    s_waitcnt lgkmcnt(10)
    v_mfma_f32_16x16x32_bf16 v[204:207], v[164:167], v[68:71], 0
    ds_read_b128 v[152:155], v59 offset:192
    ds_read_b128 v[156:159], v59 offset:256
    s_waitcnt lgkmcnt(10)
    v_mfma_f32_16x16x32_bf16 v[204:207], v[168:171], v[68:71], v[204:207]
    ds_read_b128 v[160:163], v59 offset:320
    v_mul_f32 v201, 0xbc2aaaab, v201
    s_waitcnt lgkmcnt(9)
    v_mfma_f32_16x16x32_bf16 v[204:207], v[172:175], v[68:71], v[204:207]
    v_mul_f32 v202, 0xbc2aaaab, v202
    v_mul_f32 v203, 0xbc2aaaab, v203
    ds_read_b128 v[164:167], v58 offset:192
    ds_read_b128 v[168:171], v58 offset:256
    ds_read_b128 v[172:175], v58 offset:320
    s_nop 1
    v_mul_f32 v204, 0xbc2aaaab, v204
    v_mul_f32 v205, 0xbc2aaaab, v205
    s_waitcnt lgkmcnt(10)
    v_mfma_f32_16x16x32_bf16 v[208:211], v[176:179], v[68:71], 0
    v_mul_f32 v206, 0xbc2aaaab, v206
    v_mul_f32 v207, 0xbc2aaaab, v207
    s_waitcnt lgkmcnt(8)
    v_mfma_f32_16x16x32_bf16 v[208:211], v[180:183], v[68:71], v[208:211]
    s_waitcnt lgkmcnt(6)
    v_mfma_f32_16x16x32_bf16 v[208:211], v[184:187], v[68:71], v[208:211]
    ds_read_b128 v[176:179], v60 offset:192
    s_waitcnt lgkmcnt(6)
    v_mfma_f32_4x4x4_16b_bf16 v[212:215], v[64:65], v[152:153], v[188:191]
    v_mfma_f32_4x4x4_16b_bf16 v[216:219], v[64:65], v[154:155], v[192:195]
    s_waitcnt lgkmcnt(5)
    v_mfma_f32_4x4x4_16b_bf16 v[220:223], v[64:65], v[156:157], v[196:199]
    v_mul_f32 v208, 0xbc2aaaab, v208
    v_mfma_f32_4x4x4_16b_bf16 v[224:227], v[64:65], v[158:159], v[200:203]
    v_mul_f32 v209, 0xbc2aaaab, v209
    s_waitcnt lgkmcnt(4)
    v_mfma_f32_4x4x4_16b_bf16 v[228:231], v[64:65], v[160:161], v[204:207]
    v_mul_f32 v210, 0xbc2aaaab, v210
    v_mul_f32 v211, 0xbc2aaaab, v211
    s_waitcnt lgkmcnt(3)
    v_mfma_f32_4x4x4_16b_bf16 v[236:239], v[64:65], v[164:165], v[188:191]
    v_cvt_pk_bf16_f32 v152, v212, v213
    v_mfma_f32_4x4x4_16b_bf16 v[232:235], v[64:65], v[162:163], v[208:211]
    v_cvt_pk_bf16_f32 v153, v214, v215
    v_mfma_f32_4x4x4_16b_bf16 v[240:243], v[64:65], v[166:167], v[192:195]
    v_cvt_pk_bf16_f32 v154, v216, v217
    s_waitcnt lgkmcnt(2)
    v_mfma_f32_4x4x4_16b_bf16 v[244:247], v[64:65], v[168:169], v[196:199]
    v_cvt_pk_bf16_f32 v155, v218, v219
    v_mfma_f32_4x4x4_16b_bf16 v[248:251], v[64:65], v[170:171], v[200:203]
    v_cvt_pk_bf16_f32 v156, v220, v221
    s_waitcnt lgkmcnt(1)
    v_mfma_f32_4x4x4_16b_bf16 v[212:215], v[64:65], v[172:173], v[204:207]
    v_cvt_pk_bf16_f32 v157, v222, v223
    v_mfma_f32_4x4x4_16b_bf16 v[216:219], v[64:65], v[174:175], v[208:211]
    v_cvt_pk_bf16_f32 v158, v224, v225
    v_cvt_pk_bf16_f32 v159, v226, v227
    v_cvt_pk_bf16_f32 v160, v228, v229
    s_waitcnt lgkmcnt(0)
    v_mfma_f32_4x4x4_16b_bf16 v[220:223], v[64:65], v[176:177], v[188:191]
    v_cvt_pk_bf16_f32 v161, v230, v231
    v_mfma_f32_4x4x4_16b_bf16 v[224:227], v[64:65], v[178:179], v[192:195]
    ds_read_b128 v[180:183], v60 offset:256
    ds_read_b128 v[184:187], v60 offset:320
    ds_read_b128 v[80:83], v56
    ds_read_b128 v[84:87], v56 offset:64
    ds_read_b128 v[88:91], v56 offset:128
    v_cvt_pk_bf16_f32 v162, v232, v233
    v_cvt_pk_bf16_f32 v163, v234, v235
    v_cvt_pk_bf16_f32 v164, v236, v237
    v_cvt_pk_bf16_f32 v165, v238, v239
    v_cvt_pk_bf16_f32 v166, v240, v241
    v_cvt_pk_bf16_f32 v167, v242, v243
    v_cvt_pk_bf16_f32 v168, v244, v245
    ds_read_b128 v[92:95], v56 offset:2304
    ds_read_b128 v[96:99], v56 offset:2368
    ds_read_b128 v[100:103], v56 offset:2432
    v_cvt_pk_bf16_f32 v169, v246, v247
    v_cvt_pk_bf16_f32 v170, v248, v249
    v_cvt_pk_bf16_f32 v171, v250, v251
    v_cvt_pk_bf16_f32 v172, v212, v213
    v_cvt_pk_bf16_f32 v173, v214, v215
    v_cvt_pk_bf16_f32 v174, v216, v217
    v_cvt_pk_bf16_f32 v175, v218, v219
    ds_read_b128 v[104:107], v56 offset:18432
    ds_read_b128 v[108:111], v56 offset:18496
    ds_read_b128 v[112:115], v56 offset:18560
    v_cvt_pk_bf16_f32 v176, v220, v221
    s_waitcnt lgkmcnt(10)
    v_mfma_f32_4x4x4_16b_bf16 v[228:231], v[64:65], v[180:181], v[196:199]
    v_cvt_pk_bf16_f32 v177, v222, v223
    v_mfma_f32_4x4x4_16b_bf16 v[232:235], v[64:65], v[182:183], v[200:203]
    v_cvt_pk_bf16_f32 v178, v224, v225
    s_waitcnt lgkmcnt(9)
    v_mfma_f32_4x4x4_16b_bf16 v[236:239], v[64:65], v[184:185], v[204:207]
    v_cvt_pk_bf16_f32 v179, v226, v227
    v_mfma_f32_4x4x4_16b_bf16 v[240:243], v[64:65], v[186:187], v[208:211]
    v_cvt_pk_bf16_f32 v180, v228, v229
    v_cvt_pk_bf16_f32 v181, v230, v231
    s_waitcnt lgkmcnt(8)
    v_mfma_f32_16x16x32_bf16 v[244:247], v[80:83], v[152:155], 0
    ds_read_b128 v[116:119], v56 offset:20736
    ds_read_b128 v[120:123], v56 offset:20800
    s_waitcnt lgkmcnt(9)
    v_mfma_f32_16x16x32_bf16 v[244:247], v[84:87], v[156:159], v[244:247]
    ds_read_b128 v[124:127], v56 offset:20864
    ds_read_b128 v[128:131], v56 offset:36864
    s_waitcnt lgkmcnt(10)
    v_mfma_f32_16x16x32_bf16 v[244:247], v[88:91], v[160:163], v[244:247]
    ds_read_b128 v[132:135], v56 offset:36928
    v_cvt_pk_bf16_f32 v182, v232, v233
    s_waitcnt lgkmcnt(10)
    v_mfma_f32_16x16x32_bf16 v[248:251], v[92:95], v[152:155], 0
    ds_read_b128 v[136:139], v56 offset:36992
    v_cvt_pk_bf16_f32 v183, v234, v235
    s_waitcnt lgkmcnt(10)
    v_mfma_f32_16x16x32_bf16 v[248:251], v[96:99], v[156:159], v[248:251]
    ds_read_b128 v[140:143], v56 offset:39168
    v_cvt_pk_bf16_f32 v184, v236, v237
    s_waitcnt lgkmcnt(10)
    v_mfma_f32_16x16x32_bf16 v[248:251], v[100:103], v[160:163], v[248:251]
    ds_read_b128 v[144:147], v56 offset:39232
    v_cvt_pk_bf16_f32 v185, v238, v239
    s_waitcnt lgkmcnt(10)
    v_mfma_f32_16x16x32_bf16 v[212:215], v[104:107], v[152:155], 0
    ds_read_b128 v[148:151], v56 offset:39296
    v_cvt_pk_bf16_f32 v186, v240, v241
    s_waitcnt lgkmcnt(10)
    v_mfma_f32_16x16x32_bf16 v[212:215], v[108:111], v[156:159], v[212:215]
    v_cvt_pk_bf16_f32 v187, v242, v243
    v_add_f32 v72, v244, v248
    s_waitcnt lgkmcnt(9)
    v_mfma_f32_16x16x32_bf16 v[212:215], v[112:115], v[160:163], v[212:215]
    v_add_f32 v73, v245, v249
    v_add_f32 v74, v246, v250
    s_waitcnt lgkmcnt(8)
    v_mfma_f32_16x16x32_bf16 v[216:219], v[116:119], v[152:155], 0
    v_add_f32 v75, v247, v251
    s_waitcnt lgkmcnt(7)
    v_mfma_f32_16x16x32_bf16 v[216:219], v[120:123], v[156:159], v[216:219]
    v_add_f32 v72, v72, v212
    v_add_f32 v73, v73, v213
    s_waitcnt lgkmcnt(6)
    v_mfma_f32_16x16x32_bf16 v[216:219], v[124:127], v[160:163], v[216:219]
    v_add_f32 v74, v74, v214
    v_add_f32 v75, v75, v215
    s_waitcnt lgkmcnt(5)
    v_mfma_f32_16x16x32_bf16 v[220:223], v[128:131], v[152:155], 0
    s_waitcnt lgkmcnt(4)
    v_mfma_f32_16x16x32_bf16 v[220:223], v[132:135], v[156:159], v[220:223]
    v_add_f32 v72, v72, v216
    v_add_f32 v73, v73, v217
    s_waitcnt lgkmcnt(3)
    v_mfma_f32_16x16x32_bf16 v[220:223], v[136:139], v[160:163], v[220:223]
    v_add_f32 v74, v74, v218
    v_add_f32 v75, v75, v219
    s_waitcnt lgkmcnt(2)
    v_mfma_f32_16x16x32_bf16 v[224:227], v[140:143], v[152:155], 0
    s_waitcnt lgkmcnt(1)
    v_mfma_f32_16x16x32_bf16 v[224:227], v[144:147], v[156:159], v[224:227]
    v_add_f32 v72, v72, v220
    v_add_f32 v73, v73, v221
    s_waitcnt lgkmcnt(0)
    v_mfma_f32_16x16x32_bf16 v[224:227], v[148:151], v[160:163], v[224:227]
    v_add_f32 v74, v74, v222
    v_add_f32 v75, v75, v223
    v_mfma_f32_16x16x32_bf16 v[228:231], v[80:83], v[164:167], 0
    v_mfma_f32_16x16x32_bf16 v[228:231], v[84:87], v[168:171], v[228:231]
    v_add_f32 v72, v72, v224
    v_add_f32 v73, v73, v225
    v_mfma_f32_16x16x32_bf16 v[228:231], v[88:91], v[172:175], v[228:231]
    v_add_f32 v74, v74, v226
    v_add_f32 v75, v75, v227
    v_mfma_f32_16x16x32_bf16 v[232:235], v[92:95], v[164:167], 0
    v_add_f32 v72, v72, v73
    v_add_f32 v74, v74, v75
    v_mfma_f32_16x16x32_bf16 v[232:235], v[96:99], v[168:171], v[232:235]
    v_add_f32 v72, v72, v74
    v_mfma_f32_16x16x32_bf16 v[232:235], v[100:103], v[172:175], v[232:235]
    v_mov_b32 v73, v72
    v_mfma_f32_16x16x32_bf16 v[236:239], v[104:107], v[164:167], 0
    v_permlane32_swap_b32 v72, v73
    v_mfma_f32_16x16x32_bf16 v[236:239], v[108:111], v[168:171], v[236:239]
    v_add_f32 v72, v72, v73
    v_add_f32 v76, v228, v232
    v_mfma_f32_16x16x32_bf16 v[236:239], v[112:115], v[172:175], v[236:239]
    v_mov_b32 v73, v72
    v_add_f32 v77, v229, v233
    v_mfma_f32_16x16x32_bf16 v[240:243], v[116:119], v[164:167], 0
    v_permlane16_swap_b32 v72, v73
    v_mfma_f32_16x16x32_bf16 v[240:243], v[120:123], v[168:171], v[240:243]
    v_add_f32 v72, v72, v73
    v_add_f32 v78, v230, v234
    v_mfma_f32_16x16x32_bf16 v[240:243], v[124:127], v[172:175], v[240:243]
    v_mul_f32 v72, 0xbe16c740, v72
    v_add_f32 v79, v231, v235
    v_fmamk_f32 v244, v244, 0x41622adf, v72
    v_fmamk_f32 v245, v245, 0x41622adf, v72
    v_fmamk_f32 v246, v246, 0x41622adf, v72
    v_fmamk_f32 v247, v247, 0x41622adf, v72
    v_cvt_pk_bf16_f32 v152, v244, v245
    v_cvt_pk_bf16_f32 v153, v246, v247
    v_mfma_f32_16x16x32_bf16 v[244:247], v[128:131], v[164:167], 0
    v_fmamk_f32 v248, v248, 0x41622adf, v72
    v_fmamk_f32 v249, v249, 0x41622adf, v72
    v_mfma_f32_16x16x32_bf16 v[244:247], v[132:135], v[168:171], v[244:247]
    v_fmamk_f32 v250, v250, 0x41622adf, v72
    v_add_f32 v76, v76, v236
    v_mfma_f32_16x16x32_bf16 v[244:247], v[136:139], v[172:175], v[244:247]
    v_fmamk_f32 v251, v251, 0x41622adf, v72
    v_add_f32 v77, v77, v237
    v_add_f32 v78, v78, v238
    v_cvt_pk_bf16_f32 v154, v248, v249
    v_add_f32 v79, v79, v239
    v_cvt_pk_bf16_f32 v155, v250, v251
    v_mfma_f32_16x16x32_bf16 v[248:251], v[140:143], v[164:167], 0
    v_fmamk_f32 v212, v212, 0x41622adf, v72
    v_fmamk_f32 v213, v213, 0x41622adf, v72
    v_mfma_f32_16x16x32_bf16 v[248:251], v[144:147], v[168:171], v[248:251]
    v_fmamk_f32 v214, v214, 0x41622adf, v72
    v_fmamk_f32 v215, v215, 0x41622adf, v72
    v_mfma_f32_16x16x32_bf16 v[248:251], v[148:151], v[172:175], v[248:251]
    v_cvt_pk_bf16_f32 v156, v212, v213
    v_cvt_pk_bf16_f32 v157, v214, v215
    v_mfma_f32_16x16x32_bf16 v[212:215], v[80:83], v[176:179], 0
    v_add_f32 v76, v76, v240
    v_add_f32 v77, v77, v241
    v_mfma_f32_16x16x32_bf16 v[212:215], v[84:87], v[180:183], v[212:215]
    v_fmamk_f32 v216, v216, 0x41622adf, v72
    v_add_f32 v78, v78, v242
    v_mfma_f32_16x16x32_bf16 v[212:215], v[88:91], v[184:187], v[212:215]
    v_add_f32 v79, v79, v243
    v_fmamk_f32 v217, v217, 0x41622adf, v72
    v_fmamk_f32 v218, v218, 0x41622adf, v72
    v_fmamk_f32 v219, v219, 0x41622adf, v72
    v_cvt_pk_bf16_f32 v158, v216, v217
    v_cvt_pk_bf16_f32 v159, v218, v219
    v_mfma_f32_16x16x32_bf16 v[216:219], v[92:95], v[176:179], 0
    v_fmamk_f32 v220, v220, 0x41622adf, v72
    v_fmamk_f32 v221, v221, 0x41622adf, v72
    v_mfma_f32_16x16x32_bf16 v[216:219], v[96:99], v[180:183], v[216:219]
    v_add_f32 v76, v76, v244
    v_fmamk_f32 v222, v222, 0x41622adf, v72
    v_mfma_f32_16x16x32_bf16 v[216:219], v[100:103], v[184:187], v[216:219]
    v_add_f32 v77, v77, v245
    v_add_f32 v78, v78, v246
    v_fmamk_f32 v223, v223, 0x41622adf, v72
    v_add_f32 v79, v79, v247
    v_cvt_pk_bf16_f32 v160, v220, v221
    v_cvt_pk_bf16_f32 v161, v222, v223
    v_mfma_f32_16x16x32_bf16 v[220:223], v[104:107], v[176:179], 0
    v_fmamk_f32 v224, v224, 0x41622adf, v72
    v_fmamk_f32 v225, v225, 0x41622adf, v72
    v_mfma_f32_16x16x32_bf16 v[220:223], v[108:111], v[180:183], v[220:223]
    v_fmamk_f32 v226, v226, 0x41622adf, v72
    v_fmamk_f32 v227, v227, 0x41622adf, v72
    v_mfma_f32_16x16x32_bf16 v[220:223], v[112:115], v[184:187], v[220:223]
    v_add_f32 v76, v76, v248
    v_cvt_pk_bf16_f32 v162, v224, v225
    v_add_f32 v77, v77, v249
    v_add_f32 v78, v78, v250
    v_cvt_pk_bf16_f32 v163, v226, v227
    v_mfma_f32_16x16x32_bf16 v[224:227], v[116:119], v[176:179], 0
    v_add_f32 v79, v79, v251
    v_add_f32 v76, v76, v77
    v_mfma_f32_16x16x32_bf16 v[224:227], v[120:123], v[180:183], v[224:227]
    v_add_f32 v78, v78, v79
    v_add_f32 v72, v212, v216
    v_mfma_f32_16x16x32_bf16 v[224:227], v[124:127], v[184:187], v[224:227]
    v_add_f32 v76, v76, v78
    v_add_f32 v73, v213, v217
    v_mov_b32 v77, v76
    v_add_f32 v74, v214, v218
    v_add_f32 v75, v215, v219
    v_permlane32_swap_b32 v76, v77
    v_add_f32 v72, v72, v220
    v_add_f32 v76, v76, v77
    v_add_f32 v73, v73, v221
    v_mov_b32 v77, v76
    v_add_f32 v74, v74, v222
    v_add_f32 v75, v75, v223
    v_permlane16_swap_b32 v76, v77
    v_add_f32 v72, v72, v224
    v_add_f32 v76, v76, v77
    v_add_f32 v73, v73, v225
    v_mul_f32 v76, 0xbe16c740, v76
    v_add_f32 v74, v74, v226
    v_fmamk_f32 v228, v228, 0x41622adf, v76
    v_fmamk_f32 v229, v229, 0x41622adf, v76
    v_fmamk_f32 v230, v230, 0x41622adf, v76
    v_fmamk_f32 v231, v231, 0x41622adf, v76
    v_cvt_pk_bf16_f32 v164, v228, v229
    v_cvt_pk_bf16_f32 v165, v230, v231
    v_mfma_f32_16x16x32_bf16 v[228:231], v[128:131], v[176:179], 0
    v_fmamk_f32 v232, v232, 0x41622adf, v76
    v_fmamk_f32 v233, v233, 0x41622adf, v76
    v_mfma_f32_16x16x32_bf16 v[228:231], v[132:135], v[180:183], v[228:231]
    v_fmamk_f32 v234, v234, 0x41622adf, v76
    v_fmamk_f32 v235, v235, 0x41622adf, v76
    v_mfma_f32_16x16x32_bf16 v[228:231], v[136:139], v[184:187], v[228:231]
    v_cvt_pk_bf16_f32 v166, v232, v233
    v_cvt_pk_bf16_f32 v167, v234, v235
    v_mfma_f32_16x16x32_bf16 v[232:235], v[140:143], v[176:179], 0
    v_fmamk_f32 v236, v236, 0x41622adf, v76
    v_fmamk_f32 v237, v237, 0x41622adf, v76
    v_mfma_f32_16x16x32_bf16 v[232:235], v[144:147], v[180:183], v[232:235]
    v_fmamk_f32 v238, v238, 0x41622adf, v76
    v_fmamk_f32 v239, v239, 0x41622adf, v76
    v_mfma_f32_16x16x32_bf16 v[232:235], v[148:151], v[184:187], v[232:235]
    v_cvt_pk_bf16_f32 v168, v236, v237
    v_cvt_pk_bf16_f32 v169, v238, v239
    v_fmamk_f32 v240, v240, 0x41622adf, v76
    v_add_f32 v75, v75, v227
    v_fmamk_f32 v241, v241, 0x41622adf, v76
    v_fmamk_f32 v242, v242, 0x41622adf, v76
    v_fmamk_f32 v243, v243, 0x41622adf, v76
    v_cvt_pk_bf16_f32 v170, v240, v241
    v_cvt_pk_bf16_f32 v171, v242, v243
    v_fmamk_f32 v244, v244, 0x41622adf, v76
    v_fmamk_f32 v245, v245, 0x41622adf, v76
    v_add_f32 v72, v72, v228
    v_fmamk_f32 v246, v246, 0x41622adf, v76
    v_add_f32 v73, v73, v229
    v_add_f32 v74, v74, v230
    v_fmamk_f32 v247, v247, 0x41622adf, v76
    v_add_f32 v75, v75, v231
    v_cvt_pk_bf16_f32 v172, v244, v245
    v_cvt_pk_bf16_f32 v173, v246, v247
    v_fmamk_f32 v248, v248, 0x41622adf, v76
    v_fmamk_f32 v249, v249, 0x41622adf, v76
    v_fmamk_f32 v250, v250, 0x41622adf, v76
    v_fmamk_f32 v251, v251, 0x41622adf, v76
    v_add_f32 v72, v72, v232
    v_cvt_pk_bf16_f32 v174, v248, v249
    v_add_f32 v73, v73, v233
    v_add_f32 v74, v74, v234
    v_cvt_pk_bf16_f32 v175, v250, v251
    v_add_f32 v75, v75, v235
    v_add_f32 v72, v72, v73
    v_add_f32 v74, v74, v75
    v_add_f32 v72, v72, v74
    v_mov_b32 v73, v72
    s_nop 1
    v_permlane32_swap_b32 v72, v73
    v_add_f32 v72, v72, v73
    v_mov_b32 v73, v72
    s_nop 1
    v_permlane16_swap_b32 v72, v73
    v_add_f32 v72, v72, v73
    v_mul_f32 v72, 0xbe16c740, v72
    v_fmamk_f32 v212, v212, 0x41622adf, v72
    v_fmamk_f32 v213, v213, 0x41622adf, v72
    v_fmamk_f32 v214, v214, 0x41622adf, v72
    v_fmamk_f32 v215, v215, 0x41622adf, v72
    v_cvt_pk_bf16_f32 v176, v212, v213
    v_cvt_pk_bf16_f32 v177, v214, v215
    v_fmamk_f32 v216, v216, 0x41622adf, v72
    v_fmamk_f32 v217, v217, 0x41622adf, v72
    v_fmamk_f32 v218, v218, 0x41622adf, v72
    v_fmamk_f32 v219, v219, 0x41622adf, v72
    v_cvt_pk_bf16_f32 v178, v216, v217
    v_cvt_pk_bf16_f32 v179, v218, v219
    v_fmamk_f32 v220, v220, 0x41622adf, v72
    v_fmamk_f32 v221, v221, 0x41622adf, v72
    v_fmamk_f32 v222, v222, 0x41622adf, v72
    v_fmamk_f32 v223, v223, 0x41622adf, v72
    v_cvt_pk_bf16_f32 v180, v220, v221
    v_cvt_pk_bf16_f32 v181, v222, v223
    v_fmamk_f32 v224, v224, 0x41622adf, v72
    v_fmamk_f32 v225, v225, 0x41622adf, v72
    v_fmamk_f32 v226, v226, 0x41622adf, v72
    v_fmamk_f32 v227, v227, 0x41622adf, v72
    v_cvt_pk_bf16_f32 v182, v224, v225
    v_cvt_pk_bf16_f32 v183, v226, v227
    v_fmamk_f32 v228, v228, 0x41622adf, v72
    v_fmamk_f32 v229, v229, 0x41622adf, v72
    v_fmamk_f32 v230, v230, 0x41622adf, v72
    v_fmamk_f32 v231, v231, 0x41622adf, v72
    v_cvt_pk_bf16_f32 v184, v228, v229
    v_cvt_pk_bf16_f32 v185, v230, v231
    v_fmamk_f32 v232, v232, 0x41622adf, v72
    v_fmamk_f32 v233, v233, 0x41622adf, v72
    v_fmamk_f32 v234, v234, 0x41622adf, v72
    v_fmamk_f32 v235, v235, 0x41622adf, v72
    v_cvt_pk_bf16_f32 v186, v232, v233
    v_cvt_pk_bf16_f32 v187, v234, v235
    s_waitcnt lgkmcnt(0)
    s_branch L_fuseE
L_fuseB:
    ds_read_b128 v[80:83], v56 offset:384
    ds_read_b64_tr_b16 v[152:153], v59
    ds_read_b64_tr_b16 v[154:155], v59 offset:768
    ds_read_b128 v[84:87], v56 offset:448
    ds_read_b64_tr_b16 v[156:157], v59 offset:6144
    ds_read_b64_tr_b16 v[158:159], v59 offset:6912
    ds_read_b128 v[88:91], v56 offset:512
    ds_read_b64_tr_b16 v[160:161], v59 offset:12288
    ds_read_b64_tr_b16 v[162:163], v59 offset:13056
    ds_read_b128 v[92:95], v56 offset:2688
    ds_read_b128 v[96:99], v56 offset:2752
    ds_read_b128 v[100:103], v56 offset:2816
    ds_read_b128 v[104:107], v56 offset:18816
    ds_read_b128 v[108:111], v56 offset:18880
    s_waitcnt lgkmcnt(11)
    v_mfma_f32_16x16x32_bf16 v[212:215], v[80:83], v[152:155], 0
    ds_read_b128 v[112:115], v56 offset:18944
    s_waitcnt lgkmcnt(9)
    v_mfma_f32_16x16x32_bf16 v[212:215], v[84:87], v[156:159], v[212:215]
    ds_read_b128 v[116:119], v56 offset:21120
    s_waitcnt lgkmcnt(7)
    v_mfma_f32_16x16x32_bf16 v[212:215], v[88:91], v[160:163], v[212:215]
    ds_read_b128 v[120:123], v56 offset:21184
    s_waitcnt lgkmcnt(7)
    v_mfma_f32_16x16x32_bf16 v[216:219], v[92:95], v[152:155], 0
    ds_read_b128 v[124:127], v56 offset:21248
    s_waitcnt lgkmcnt(7)
    v_mfma_f32_16x16x32_bf16 v[216:219], v[96:99], v[156:159], v[216:219]
    ds_read_b128 v[128:131], v56 offset:37248
    s_waitcnt lgkmcnt(7)
    v_mfma_f32_16x16x32_bf16 v[216:219], v[100:103], v[160:163], v[216:219]
    ds_read_b128 v[132:135], v56 offset:37312
    s_waitcnt lgkmcnt(7)
    v_mfma_f32_16x16x32_bf16 v[220:223], v[104:107], v[152:155], 0
    ds_read_b128 v[136:139], v56 offset:37376
    s_waitcnt lgkmcnt(7)
    v_mfma_f32_16x16x32_bf16 v[220:223], v[108:111], v[156:159], v[220:223]
    ds_read_b128 v[140:143], v56 offset:39552
    v_add_f32 v72, v212, v216
    s_waitcnt lgkmcnt(7)
    v_mfma_f32_16x16x32_bf16 v[220:223], v[112:115], v[160:163], v[220:223]
    ds_read_b128 v[144:147], v56 offset:39616
    v_add_f32 v73, v213, v217
    s_waitcnt lgkmcnt(7)
    v_mfma_f32_16x16x32_bf16 v[224:227], v[116:119], v[152:155], 0
    ds_read_b128 v[148:151], v56 offset:39680
    v_add_f32 v74, v214, v218
    s_waitcnt lgkmcnt(7)
    v_mfma_f32_16x16x32_bf16 v[224:227], v[120:123], v[156:159], v[224:227]
    ds_read_b64_tr_b16 v[164:165], v58
    ds_read_b64_tr_b16 v[166:167], v58 offset:768
    s_waitcnt lgkmcnt(8)
    v_mfma_f32_16x16x32_bf16 v[224:227], v[124:127], v[160:163], v[224:227]
    ds_read_b64_tr_b16 v[168:169], v58 offset:6144
    ds_read_b64_tr_b16 v[170:171], v58 offset:6912
    s_waitcnt lgkmcnt(9)
    v_mfma_f32_16x16x32_bf16 v[228:231], v[128:131], v[152:155], 0
    ds_read_b64_tr_b16 v[172:173], v58 offset:12288
    ds_read_b64_tr_b16 v[174:175], v58 offset:13056
    s_waitcnt lgkmcnt(10)
    v_mfma_f32_16x16x32_bf16 v[228:231], v[132:135], v[156:159], v[228:231]
    v_add_f32 v75, v215, v219
    v_add_f32 v72, v72, v220
    s_waitcnt lgkmcnt(9)
    v_mfma_f32_16x16x32_bf16 v[228:231], v[136:139], v[160:163], v[228:231]
    v_add_f32 v73, v73, v221
    v_add_f32 v74, v74, v222
    s_waitcnt lgkmcnt(8)
    v_mfma_f32_16x16x32_bf16 v[232:235], v[140:143], v[152:155], 0
    v_add_f32 v75, v75, v223
    v_add_f32 v72, v72, v224
    s_waitcnt lgkmcnt(7)
    v_mfma_f32_16x16x32_bf16 v[232:235], v[144:147], v[156:159], v[232:235]
    v_add_f32 v73, v73, v225
    v_add_f32 v74, v74, v226
    s_waitcnt lgkmcnt(6)
    v_mfma_f32_16x16x32_bf16 v[232:235], v[148:151], v[160:163], v[232:235]
    v_add_f32 v75, v75, v227
    v_add_f32 v72, v72, v228
    v_add_f32 v73, v73, v229
    s_waitcnt lgkmcnt(4)
    v_mfma_f32_16x16x32_bf16 v[236:239], v[80:83], v[164:167], 0
    v_add_f32 v74, v74, v230
    v_add_f32 v75, v75, v231
    s_waitcnt lgkmcnt(2)
    v_mfma_f32_16x16x32_bf16 v[236:239], v[84:87], v[168:171], v[236:239]
    v_add_f32 v72, v72, v232
    v_add_f32 v73, v73, v233
    s_waitcnt lgkmcnt(0)
    v_mfma_f32_16x16x32_bf16 v[236:239], v[88:91], v[172:175], v[236:239]
    v_add_f32 v74, v74, v234
    v_add_f32 v75, v75, v235
    v_mfma_f32_16x16x32_bf16 v[240:243], v[92:95], v[164:167], 0
    v_add_f32 v72, v72, v73
    v_add_f32 v74, v74, v75
    v_mfma_f32_16x16x32_bf16 v[240:243], v[96:99], v[168:171], v[240:243]
    v_add_f32 v72, v72, v74
    v_mfma_f32_16x16x32_bf16 v[240:243], v[100:103], v[172:175], v[240:243]
    v_mov_b32 v73, v72
    v_mfma_f32_16x16x32_bf16 v[244:247], v[104:107], v[164:167], 0
    v_permlane32_swap_b32 v72, v73
    v_mfma_f32_16x16x32_bf16 v[244:247], v[108:111], v[168:171], v[244:247]
    v_add_f32 v72, v72, v73
    v_add_f32 v76, v236, v240
    v_mfma_f32_16x16x32_bf16 v[244:247], v[112:115], v[172:175], v[244:247]
    v_mov_b32 v73, v72
    v_add_f32 v77, v237, v241
    v_mfma_f32_16x16x32_bf16 v[248:251], v[116:119], v[164:167], 0
    v_permlane16_swap_b32 v72, v73
    v_mfma_f32_16x16x32_bf16 v[248:251], v[120:123], v[168:171], v[248:251]
    v_add_f32 v72, v72, v73
    v_add_f32 v78, v238, v242
    v_mfma_f32_16x16x32_bf16 v[248:251], v[124:127], v[172:175], v[248:251]
    v_mul_f32 v72, 0xbdd105ec, v72
    v_add_f32 v79, v239, v243
    v_fmamk_f32 v212, v212, 0x411cc471, v72
    v_fmamk_f32 v213, v213, 0x411cc471, v72
    v_fmamk_f32 v214, v214, 0x411cc471, v72
    v_fmamk_f32 v215, v215, 0x411cc471, v72
    v_cvt_pk_bf16_f32 v152, v212, v213
    v_cvt_pk_bf16_f32 v153, v214, v215
    v_mfma_f32_16x16x32_bf16 v[212:215], v[128:131], v[164:167], 0
    v_fmamk_f32 v216, v216, 0x411cc471, v72
    v_fmamk_f32 v217, v217, 0x411cc471, v72
    v_mfma_f32_16x16x32_bf16 v[212:215], v[132:135], v[168:171], v[212:215]
    ds_read_b64_tr_b16 v[176:177], v60
    ds_read_b64_tr_b16 v[178:179], v60 offset:768
    v_mfma_f32_16x16x32_bf16 v[212:215], v[136:139], v[172:175], v[212:215]
    v_fmamk_f32 v218, v218, 0x411cc471, v72
    v_add_f32 v76, v76, v244
    v_fmamk_f32 v219, v219, 0x411cc471, v72
    v_add_f32 v77, v77, v245
    v_add_f32 v78, v78, v246
    v_cvt_pk_bf16_f32 v154, v216, v217
    v_add_f32 v79, v79, v247
    v_cvt_pk_bf16_f32 v155, v218, v219
    v_mfma_f32_16x16x32_bf16 v[216:219], v[140:143], v[164:167], 0
    ds_read_b64_tr_b16 v[180:181], v60 offset:6144
    ds_read_b64_tr_b16 v[182:183], v60 offset:6912
    v_mfma_f32_16x16x32_bf16 v[216:219], v[144:147], v[168:171], v[216:219]
    ds_read_b64_tr_b16 v[184:185], v60 offset:12288
    ds_read_b64_tr_b16 v[186:187], v60 offset:13056
    v_mfma_f32_16x16x32_bf16 v[216:219], v[148:151], v[172:175], v[216:219]
    v_fmamk_f32 v220, v220, 0x411cc471, v72
    v_fmamk_f32 v221, v221, 0x411cc471, v72
    v_fmamk_f32 v222, v222, 0x411cc471, v72
    v_fmamk_f32 v223, v223, 0x411cc471, v72
    v_cvt_pk_bf16_f32 v156, v220, v221
    v_cvt_pk_bf16_f32 v157, v222, v223
    v_add_f32 v76, v76, v248
    v_add_f32 v77, v77, v249
    v_fmamk_f32 v224, v224, 0x411cc471, v72
    s_waitcnt lgkmcnt(4)
    v_mfma_f32_16x16x32_bf16 v[220:223], v[80:83], v[176:179], 0
    v_add_f32 v78, v78, v250
    v_add_f32 v79, v79, v251
    v_fmamk_f32 v225, v225, 0x411cc471, v72
    v_fmamk_f32 v226, v226, 0x411cc471, v72
    v_fmamk_f32 v227, v227, 0x411cc471, v72
    v_cvt_pk_bf16_f32 v158, v224, v225
    v_cvt_pk_bf16_f32 v159, v226, v227
    v_mfma_f32_16x16x32_bf16 v[224:227], v[92:95], v[176:179], 0
    v_fmamk_f32 v228, v228, 0x411cc471, v72
    v_fmamk_f32 v229, v229, 0x411cc471, v72
    v_add_f32 v76, v76, v212
    s_waitcnt lgkmcnt(2)
    v_mfma_f32_16x16x32_bf16 v[220:223], v[84:87], v[180:183], v[220:223]
    v_fmamk_f32 v230, v230, 0x411cc471, v72
    v_add_f32 v77, v77, v213
    s_waitcnt lgkmcnt(0)
    v_mfma_f32_16x16x32_bf16 v[220:223], v[88:91], v[184:187], v[220:223]
    v_add_f32 v78, v78, v214
    v_fmamk_f32 v231, v231, 0x411cc471, v72
    v_mfma_f32_16x16x32_bf16 v[224:227], v[96:99], v[180:183], v[224:227]
    v_add_f32 v79, v79, v215
    v_cvt_pk_bf16_f32 v160, v228, v229
    v_mfma_f32_16x16x32_bf16 v[224:227], v[100:103], v[184:187], v[224:227]
    v_cvt_pk_bf16_f32 v161, v230, v231
    v_fmamk_f32 v232, v232, 0x411cc471, v72
    v_mfma_f32_16x16x32_bf16 v[228:231], v[104:107], v[176:179], 0
    v_fmamk_f32 v233, v233, 0x411cc471, v72
    v_fmamk_f32 v234, v234, 0x411cc471, v72
    v_mfma_f32_16x16x32_bf16 v[228:231], v[108:111], v[180:183], v[228:231]
    v_fmamk_f32 v235, v235, 0x411cc471, v72
    v_add_f32 v76, v76, v216
    v_mfma_f32_16x16x32_bf16 v[228:231], v[112:115], v[184:187], v[228:231]
    v_cvt_pk_bf16_f32 v162, v232, v233
    v_add_f32 v77, v77, v217
    v_add_f32 v78, v78, v218
    v_cvt_pk_bf16_f32 v163, v234, v235
    v_mfma_f32_16x16x32_bf16 v[232:235], v[116:119], v[176:179], 0
    v_add_f32 v79, v79, v219
    v_add_f32 v76, v76, v77
    v_mfma_f32_16x16x32_bf16 v[232:235], v[120:123], v[180:183], v[232:235]
    v_add_f32 v78, v78, v79
    v_add_f32 v72, v220, v224
    v_mfma_f32_16x16x32_bf16 v[232:235], v[124:127], v[184:187], v[232:235]
    v_add_f32 v76, v76, v78
    v_add_f32 v73, v221, v225
    v_mov_b32 v77, v76
    v_add_f32 v74, v222, v226
    v_add_f32 v75, v223, v227
    v_permlane32_swap_b32 v76, v77
    v_add_f32 v72, v72, v228
    v_add_f32 v76, v76, v77
    v_add_f32 v73, v73, v229
    v_mov_b32 v77, v76
    v_add_f32 v74, v74, v230
    v_add_f32 v75, v75, v231
    v_permlane16_swap_b32 v76, v77
    v_add_f32 v72, v72, v232
    v_add_f32 v76, v76, v77
    v_add_f32 v73, v73, v233
    v_mul_f32 v76, 0xbdd105ec, v76
    v_add_f32 v74, v74, v234
    v_fmamk_f32 v236, v236, 0x411cc471, v76
    v_fmamk_f32 v237, v237, 0x411cc471, v76
    v_fmamk_f32 v238, v238, 0x411cc471, v76
    v_fmamk_f32 v239, v239, 0x411cc471, v76
    v_cvt_pk_bf16_f32 v164, v236, v237
    v_cvt_pk_bf16_f32 v165, v238, v239
    v_mfma_f32_16x16x32_bf16 v[236:239], v[128:131], v[176:179], 0
    v_fmamk_f32 v240, v240, 0x411cc471, v76
    v_fmamk_f32 v241, v241, 0x411cc471, v76
    v_mfma_f32_16x16x32_bf16 v[236:239], v[132:135], v[180:183], v[236:239]
    v_fmamk_f32 v242, v242, 0x411cc471, v76
    v_fmamk_f32 v243, v243, 0x411cc471, v76
    v_mfma_f32_16x16x32_bf16 v[236:239], v[136:139], v[184:187], v[236:239]
    v_cvt_pk_bf16_f32 v166, v240, v241
    v_cvt_pk_bf16_f32 v167, v242, v243
    v_mfma_f32_16x16x32_bf16 v[240:243], v[140:143], v[176:179], 0
    v_fmamk_f32 v244, v244, 0x411cc471, v76
    v_fmamk_f32 v245, v245, 0x411cc471, v76
    v_mfma_f32_16x16x32_bf16 v[240:243], v[144:147], v[180:183], v[240:243]
    v_fmamk_f32 v246, v246, 0x411cc471, v76
    v_fmamk_f32 v247, v247, 0x411cc471, v76
    v_mfma_f32_16x16x32_bf16 v[240:243], v[148:151], v[184:187], v[240:243]
    v_cvt_pk_bf16_f32 v168, v244, v245
    v_cvt_pk_bf16_f32 v169, v246, v247
    v_fmamk_f32 v248, v248, 0x411cc471, v76
    v_add_f32 v75, v75, v235
    v_fmamk_f32 v249, v249, 0x411cc471, v76
    v_fmamk_f32 v250, v250, 0x411cc471, v76
    v_fmamk_f32 v251, v251, 0x411cc471, v76
    v_cvt_pk_bf16_f32 v170, v248, v249
    v_cvt_pk_bf16_f32 v171, v250, v251
    v_fmamk_f32 v212, v212, 0x411cc471, v76
    v_fmamk_f32 v213, v213, 0x411cc471, v76
    v_add_f32 v72, v72, v236
    v_fmamk_f32 v214, v214, 0x411cc471, v76
    v_add_f32 v73, v73, v237
    v_add_f32 v74, v74, v238
    v_fmamk_f32 v215, v215, 0x411cc471, v76
    v_add_f32 v75, v75, v239
    v_cvt_pk_bf16_f32 v172, v212, v213
    v_cvt_pk_bf16_f32 v173, v214, v215
    v_fmamk_f32 v216, v216, 0x411cc471, v76
    v_fmamk_f32 v217, v217, 0x411cc471, v76
    v_fmamk_f32 v218, v218, 0x411cc471, v76
    v_fmamk_f32 v219, v219, 0x411cc471, v76
    v_add_f32 v72, v72, v240
    v_cvt_pk_bf16_f32 v174, v216, v217
    v_add_f32 v73, v73, v241
    v_add_f32 v74, v74, v242
    v_cvt_pk_bf16_f32 v175, v218, v219
    v_add_f32 v75, v75, v243
    v_add_f32 v72, v72, v73
    v_add_f32 v74, v74, v75
    v_add_f32 v72, v72, v74
    v_mov_b32 v73, v72
    s_nop 1
    v_permlane32_swap_b32 v72, v73
    v_add_f32 v72, v72, v73
    v_mov_b32 v73, v72
    s_nop 1
    v_permlane16_swap_b32 v72, v73
    v_add_f32 v72, v72, v73
    v_mul_f32 v72, 0xbdd105ec, v72
    v_fmamk_f32 v220, v220, 0x411cc471, v72
    v_fmamk_f32 v221, v221, 0x411cc471, v72
    v_fmamk_f32 v222, v222, 0x411cc471, v72
    v_fmamk_f32 v223, v223, 0x411cc471, v72
    v_cvt_pk_bf16_f32 v176, v220, v221
    v_cvt_pk_bf16_f32 v177, v222, v223
    v_fmamk_f32 v224, v224, 0x411cc471, v72
    v_fmamk_f32 v225, v225, 0x411cc471, v72
    v_fmamk_f32 v226, v226, 0x411cc471, v72
    v_fmamk_f32 v227, v227, 0x411cc471, v72
    v_cvt_pk_bf16_f32 v178, v224, v225
    v_cvt_pk_bf16_f32 v179, v226, v227
    v_fmamk_f32 v228, v228, 0x411cc471, v72
    v_fmamk_f32 v229, v229, 0x411cc471, v72
    v_fmamk_f32 v230, v230, 0x411cc471, v72
    v_fmamk_f32 v231, v231, 0x411cc471, v72
    v_cvt_pk_bf16_f32 v180, v228, v229
    v_cvt_pk_bf16_f32 v181, v230, v231
    v_fmamk_f32 v232, v232, 0x411cc471, v72
    v_fmamk_f32 v233, v233, 0x411cc471, v72
    v_fmamk_f32 v234, v234, 0x411cc471, v72
    v_fmamk_f32 v235, v235, 0x411cc471, v72
    v_cvt_pk_bf16_f32 v182, v232, v233
    v_cvt_pk_bf16_f32 v183, v234, v235
    v_fmamk_f32 v236, v236, 0x411cc471, v72
    v_fmamk_f32 v237, v237, 0x411cc471, v72
    v_fmamk_f32 v238, v238, 0x411cc471, v72
    v_fmamk_f32 v239, v239, 0x411cc471, v72
    v_cvt_pk_bf16_f32 v184, v236, v237
    v_cvt_pk_bf16_f32 v185, v238, v239
    v_fmamk_f32 v240, v240, 0x411cc471, v72
    v_fmamk_f32 v241, v241, 0x411cc471, v72
    v_fmamk_f32 v242, v242, 0x411cc471, v72
    v_fmamk_f32 v243, v243, 0x411cc471, v72
    v_cvt_pk_bf16_f32 v186, v240, v241
    v_cvt_pk_bf16_f32 v187, v242, v243
    s_waitcnt lgkmcnt(0)
    s_nop 0
L_fuseE:
    s_cmp_ge_u32 s36, 4
    s_cbranch_scc1 L_S1
    s_barrier
    v_lshlrev_b32 v58, 4, v62
    v_and_b32 v75, 63, v0
    v_add_u32 v58, s66, v58
    v_and_b32 v76, 1, v75
    ds_write_b128 v58, v[152:155]
    ds_write_b128 v58, v[156:159] offset:1024
    ds_write_b128 v58, v[160:163] offset:2048
    v_lshlrev_b32 v76, 4, v76
    ds_write_b128 v58, v[164:167] offset:3072
    v_mov_b32 v110, 0x3f80
    ds_write_b128 v58, v[168:171] offset:4096
    v_lshlrev_b32 v76, v76, v110
    ds_write_b128 v58, v[172:175] offset:5120
    v_cndmask_b32_e64 v76, 0, v76, s[42:43]
    ds_write_b128 v58, v[176:179] offset:6144
    v_and_b32 v111, 2, v75
    ds_write_b128 v58, v[180:183] offset:7168
    v_cmp_eq_u32_e64 s[70:71], 0, v111
    ds_write_b128 v58, v[184:187] offset:8192
    s_nop 0
    v_cndmask_b32_e64 v110, 0, v76, s[70:71]
    v_cndmask_b32_e64 v111, v76, 0, s[70:71]
    v_and_b32 v74, 63, v0
    v_lshlrev_b32 v74, 4, v74
    v_add_u32 v74, 0x9000, v74
    s_waitcnt vmcnt(0) lgkmcnt(0)
    s_barrier
    s_setprio 1
    v_mfma_f32_16x16x32_bf16 v[102:105], v[16:19], v[16:19], 0
    ds_read_b128 v[112:115], v74
    ds_read_b128 v[116:119], v74 offset:1024
    v_mfma_f32_16x16x32_bf16 v[102:105], v[22:25], v[22:25], v[102:105]
    ds_read_b128 v[120:123], v74 offset:2048
    ds_read_b128 v[124:127], v74 offset:3072
    v_mfma_f32_16x16x32_bf16 v[102:105], v[28:31], v[28:31], v[102:105]
    ds_read_b128 v[128:131], v74 offset:4096
    ds_read_b128 v[132:135], v74 offset:5120
    v_mfma_f32_16x16x32_bf16 v[106:109], v[10:13], v[16:19], 0
    ds_read_b128 v[136:139], v74 offset:6144
    v_mfma_f32_16x16x32_bf16 v[106:109], v[10:13], v[22:25], v[106:109]
    ds_read_b128 v[140:143], v74 offset:7168
    v_mfma_f32_16x16x32_bf16 v[106:109], v[10:13], v[28:31], v[106:109]
    ds_read_b128 v[144:147], v74 offset:8192
    ds_read_b128 v[148:151], v74 offset:9216
    ds_read_b128 v[152:155], v74 offset:10240
    s_nop 4
    v_mov_b32_dpp v9, v106 quad_perm:[0,1,2,3] row_mask:0x1 bank_mask:0xf
    s_waitcnt lgkmcnt(10)
    v_mfma_f32_16x16x32_bf16 v[86:89], v[112:115], v[16:19], 0
    ds_read_b128 v[156:159], v74 offset:11264
    s_waitcnt lgkmcnt(10)
    v_mfma_f32_16x16x32_bf16 v[86:89], v[116:119], v[22:25], v[86:89]
    ds_read_b128 v[160:163], v74 offset:12288
    s_waitcnt lgkmcnt(10)
    v_mfma_f32_16x16x32_bf16 v[86:89], v[120:123], v[28:31], v[86:89]
    ds_read_b128 v[164:167], v74 offset:13312
    s_waitcnt lgkmcnt(10)
    v_mfma_f32_16x16x32_bf16 v[90:93], v[124:127], v[16:19], 0
    ds_read_b128 v[168:171], v74 offset:14336
    s_waitcnt lgkmcnt(10)
    v_mfma_f32_16x16x32_bf16 v[90:93], v[128:131], v[22:25], v[90:93]
    ds_read_b128 v[172:175], v74 offset:15360
    v_cvt_pk_bf16_f32 v75, v88, v89
    s_waitcnt lgkmcnt(10)
    v_mfma_f32_16x16x32_bf16 v[90:93], v[132:135], v[28:31], v[90:93]
    ds_read_b128 v[176:179], v74 offset:16384
    s_waitcnt lgkmcnt(10)
    v_mfma_f32_16x16x32_bf16 v[94:97], v[136:139], v[16:19], 0
    ds_read_b128 v[180:183], v74 offset:17408
    s_waitcnt lgkmcnt(10)
    v_mfma_f32_16x16x32_bf16 v[94:97], v[140:143], v[22:25], v[94:97]
    ds_read_b128 v[184:187], v74 offset:18432
    v_cvt_pk_bf16_f32 v76, v90, v91
    s_waitcnt lgkmcnt(10)
    v_mfma_f32_16x16x32_bf16 v[94:97], v[144:147], v[28:31], v[94:97]
    s_mov_b64 exec, s[42:43]
    ds_write_b128 v4, v[102:105] offset:768
    s_mov_b64 exec, -1
    ds_read_b32 v102, v6
    v_cvt_pk_bf16_f32 v77, v92, v93
    s_waitcnt lgkmcnt(8)
    v_mfma_f32_16x16x32_bf16 v[90:93], v[160:163], v[16:19], 0
    ds_read_b128 v[188:191], v74 offset:19456
    v_cvt_pk_bf16_f32 v78, v94, v95
    s_waitcnt lgkmcnt(8)
    v_mfma_f32_16x16x32_bf16 v[90:93], v[164:167], v[22:25], v[90:93]
    ds_read_b128 v[192:195], v74 offset:20480
    v_cvt_pk_bf16_f32 v79, v96, v97
    s_waitcnt lgkmcnt(8)
    v_mfma_f32_16x16x32_bf16 v[90:93], v[168:171], v[28:31], v[90:93]
    ds_read_b128 v[196:199], v74 offset:21504
    v_mul_f32 v104, v9, v9
    s_waitcnt lgkmcnt(8)
    v_mfma_f32_16x16x32_bf16 v[94:97], v[172:175], v[16:19], 0
    ds_read_b128 v[200:203], v74 offset:22528
    s_waitcnt lgkmcnt(8)
    v_mfma_f32_16x16x32_bf16 v[94:97], v[176:179], v[22:25], v[94:97]
    ds_read_b128 v[204:207], v74 offset:23552
    v_cvt_pk_bf16_f32 v82, v90, v91
    s_waitcnt lgkmcnt(8)
    v_mfma_f32_16x16x32_bf16 v[94:97], v[180:183], v[28:31], v[94:97]
    ds_read_b128 v[208:211], v74 offset:24576
    ds_read_b128 v[212:215], v74 offset:25600
    ds_read_b128 v[216:219], v74 offset:26624
    ds_read_b128 v[220:223], v74 offset:27648
    ds_read_b128 v[224:227], v74 offset:28672
    ds_read_b128 v[228:231], v74 offset:29696
    ds_read_b128 v[232:235], v74 offset:30720
    ds_read_b128 v[236:239], v74 offset:31744
    ds_read_b128 v[240:243], v74 offset:32768
    ds_read_b128 v[244:247], v74 offset:33792
    ds_read_b128 v[248:251], v74 offset:34816
    ds_read_b128 v[252:255], v74 offset:35840
    v_cvt_pk_bf16_f32 v74, v86, v87
    v_mfma_f32_16x16x32_bf16 v[86:89], v[148:151], v[16:19], 0
    v_cvt_pk_bf16_f32 v83, v92, v93
    v_cvt_pk_bf16_f32 v84, v94, v95
    v_mfma_f32_16x16x32_bf16 v[86:89], v[152:155], v[22:25], v[86:89]
    v_cvt_pk_bf16_f32 v85, v96, v97
    s_waitcnt lgkmcnt(15)
    v_fmamk_f32 v102, v104, 0xbc2aaaab, v102
    v_mfma_f32_16x16x32_bf16 v[86:89], v[156:159], v[28:31], v[86:89]
    v_max_f32 v102, 0, v102
    v_mfma_f32_16x16x32_bf16 v[98:101], v[16:19], v[74:77], 0
    v_add_f32 v102, 0x3a7ba882, v102
    v_mov_b32 v76, v110
    v_rsq_f32 v103, v102
    v_cvt_pk_bf16_f32 v80, v86, v87
    v_cvt_pk_bf16_f32 v81, v88, v89
    v_mfma_f32_16x16x32_bf16 v[86:89], v[16:19], v[184:187], 0
    v_mov_b32 v77, v111
    v_mfma_f32_16x16x32_bf16 v[98:101], v[22:25], v[78:81], v[98:101]
    v_mfma_f32_16x16x32_bf16 v[98:101], v[28:31], v[82:85], v[98:101]
    v_mov_b32 v82, v110
    v_mov_b32 v83, v111
    s_waitcnt lgkmcnt(15)
    v_mfma_f32_16x16x32_bf16 v[86:89], v[22:25], v[188:191], v[86:89]
    s_waitcnt lgkmcnt(15)
    v_mfma_f32_16x16x32_bf16 v[86:89], v[28:31], v[192:195], v[86:89]
    s_mov_b64 exec, s[42:43]
    ds_write_b128 v4, v[98:101]
    s_mov_b64 exec, -1
    s_waitcnt lgkmcnt(15)
    v_mfma_f32_16x16x32_bf16 v[90:93], v[16:19], v[196:199], 0
    ds_read_b128 v[98:101], v5
    s_nop 1
    v_cvt_pk_bf16_f32 v74, v86, v87
    s_waitcnt lgkmcnt(15)
    v_mfma_f32_16x16x32_bf16 v[90:93], v[22:25], v[200:203], v[90:93]
    v_cvt_pk_bf16_f32 v75, v88, v89
    s_waitcnt lgkmcnt(14)
    v_mfma_f32_16x16x32_bf16 v[90:93], v[28:31], v[204:207], v[90:93]
    s_waitcnt lgkmcnt(13)
    v_mfma_f32_16x16x32_bf16 v[86:89], v[16:19], v[208:211], 0
    s_waitcnt lgkmcnt(12)
    v_mfma_f32_16x16x32_bf16 v[86:89], v[22:25], v[212:215], v[86:89]
    v_cvt_pk_bf16_f32 v78, v90, v91
    v_cvt_pk_bf16_f32 v79, v92, v93
    s_waitcnt lgkmcnt(11)
    v_mfma_f32_16x16x32_bf16 v[86:89], v[28:31], v[216:219], v[86:89]
    s_waitcnt lgkmcnt(10)
    v_mfma_f32_16x16x32_bf16 v[90:93], v[16:19], v[220:223], 0
    s_nop 3
    v_cvt_pk_bf16_f32 v80, v86, v87
    v_cvt_pk_bf16_f32 v81, v88, v89
    s_waitcnt lgkmcnt(0)
    v_mul_f32_dpp v98, v103, v98 quad_perm:[0,0,0,0] row_mask:0xf bank_mask:0xf
    v_mfma_f32_16x16x32_bf16 v[90:93], v[22:25], v[224:227], v[90:93]
    v_mul_f32_dpp v99, v103, v99 quad_perm:[1,1,1,1] row_mask:0xf bank_mask:0xf
    v_mul_f32_dpp v100, v103, v100 quad_perm:[2,2,2,2] row_mask:0xf bank_mask:0xf
    v_mfma_f32_16x16x32_bf16 v[90:93], v[28:31], v[228:231], v[90:93]
    v_mul_f32_dpp v101, v103, v101 quad_perm:[3,3,3,3] row_mask:0xf bank_mask:0xf
    v_max3_f32 v104, v98, v99, v100
    v_max_f32 v104, v104, v101
    v_mul_f32_e64 v104, -v104, v103
    v_fma_f32 v98, v98, v103, v104
    v_fma_f32 v99, v99, v103, v104
    v_mfma_f32_16x16x32_bf16 v[86:89], v[16:19], v[232:235], 0
    v_fma_f32 v100, v100, v103, v104
    v_fma_f32 v101, v101, v103, v104
    v_mfma_f32_16x16x32_bf16 v[86:89], v[22:25], v[236:239], v[86:89]
    v_exp_f32 v98, v98
    v_mfma_f32_16x16x32_bf16 v[86:89], v[28:31], v[240:243], v[86:89]
    v_exp_f32 v99, v99
    v_exp_f32 v100, v100
    v_exp_f32 v101, v101
    v_add_f32 v105, v98, v99
    v_add_f32 v104, v100, v101
    v_mul_f32_dpp v98, v103, v98 quad_perm:[0,0,0,0] row_mask:0xf bank_mask:0xf
    v_add_f32 v105, v105, v104
    v_mul_f32_dpp v99, v103, v99 quad_perm:[1,1,1,1] row_mask:0xf bank_mask:0xf
    v_rcp_f32 v105, v105
    v_mul_f32_dpp v100, v103, v100 quad_perm:[2,2,2,2] row_mask:0xf bank_mask:0xf
    v_mul_f32_dpp v101, v103, v101 quad_perm:[3,3,3,3] row_mask:0xf bank_mask:0xf
    v_mul_f32 v98, v98, v105
    v_mul_f32 v99, v99, v105
    v_mul_f32 v100, v100, v105
    v_mul_f32 v101, v101, v105
    v_cvt_pk_bf16_f32 v102, v98, v99
    v_cvt_pk_bf16_f32 v103, v100, v101
    v_cvt_pk_bf16_f32 v84, v90, v91
    ds_write_b64 v7, v[102:103]
    s_mov_b64 exec, s[42:43]
    ds_read_b64 v[14:15], v8
    ds_read_b64 v[20:21], v8
    ds_read_b64 v[26:27], v8
    ds_read_b64 v[32:33], v8
    s_mov_b64 exec, -1
    v_cvt_pk_bf16_f32 v85, v92, v93
    v_mfma_f32_16x16x32_bf16 v[90:93], v[16:19], v[244:247], 0
    v_mov_b32 v55, 0
    v_mov_b32 v60, 0
    v_mfma_f32_16x16x32_bf16 v[90:93], v[22:25], v[248:251], v[90:93]
    v_mov_b32 v61, 0
    v_mov_b32 v66, 0
    v_mfma_f32_16x16x32_bf16 v[90:93], v[28:31], v[252:255], v[90:93]
    v_mov_b32 v67, 0
    v_mov_b32 v72, 0
    v_mov_b32 v73, 0
    s_waitcnt lgkmcnt(3)
    v_mfma_f32_16x16x32_bf16 v[94:97], v[74:77], v[14:17], 0
    v_cvt_pk_bf16_f32 v74, v86, v87
    v_cvt_pk_bf16_f32 v75, v88, v89
    s_waitcnt lgkmcnt(2)
    v_mfma_f32_16x16x32_bf16 v[98:101], v[76:79], v[18:21], 0
    v_cvt_pk_bf16_f32 v78, v90, v91
    v_cvt_pk_bf16_f32 v79, v92, v93
    v_cvt_pk_bf16_f32 v102, v94, v95
    v_cvt_pk_bf16_f32 v103, v96, v97
    v_mfma_f32_16x16x32_bf16 v[94:97], v[80:83], v[20:23], 0
    s_nop 1
    v_cvt_pk_bf16_f32 v104, v98, v99
    v_cvt_pk_bf16_f32 v105, v100, v101
    s_waitcnt lgkmcnt(1)
    v_mfma_f32_16x16x32_bf16 v[98:101], v[82:85], v[24:27], 0
    s_mov_b64 exec, s[44:45]
    ds_write_b128 v54, v[102:105]
    s_mov_b64 exec, -1
    v_cvt_pk_bf16_f32 v106, v94, v95
    v_cvt_pk_bf16_f32 v107, v96, v97
    v_mfma_f32_16x16x32_bf16 v[94:97], v[74:77], v[26:29], 0
    s_nop 1
    v_cvt_pk_bf16_f32 v108, v98, v99
    v_cvt_pk_bf16_f32 v109, v100, v101
    s_waitcnt lgkmcnt(1)
    v_mfma_f32_16x16x32_bf16 v[98:101], v[76:79], v[30:33], 0
    s_mov_b64 exec, s[44:45]
    ds_write_b128 v54, v[106:109] offset:64
    s_mov_b64 exec, -1
    v_cvt_pk_bf16_f32 v102, v94, v95
    v_cvt_pk_bf16_f32 v103, v96, v97
    s_nop 2
    v_cvt_pk_bf16_f32 v104, v98, v99
    v_cvt_pk_bf16_f32 v105, v100, v101
    s_mov_b64 exec, s[44:45]
    ds_write_b128 v54, v[102:105] offset:128
    s_mov_b64 exec, -1
    v_mov_b32 v54, 0
    s_waitcnt lgkmcnt(0)
    s_barrier
    ds_read_b128 v[16:19], v1
    ds_read_b128 v[22:25], v1 offset:64
    ds_read_b128 v[28:31], v1 offset:128
    ds_read_b128 v[36:39], v2
    ds_read_b128 v[42:45], v2 offset:64
    ds_read_b128 v[48:51], v2 offset:128
    ds_read_b128 v[56:59], v3
    ds_read_b128 v[62:65], v3 offset:64
    ds_read_b128 v[68:71], v3 offset:128
    s_waitcnt lgkmcnt(8)
    v_mfma_f32_16x16x32_bf16 v[102:105], v[16:19], v[16:19], 0
    s_waitcnt lgkmcnt(7)
    v_mfma_f32_16x16x32_bf16 v[102:105], v[22:25], v[22:25], v[102:105]
    s_waitcnt lgkmcnt(6)
    v_mfma_f32_16x16x32_bf16 v[102:105], v[28:31], v[28:31], v[102:105]
    v_mfma_f32_16x16x32_bf16 v[106:109], v[10:13], v[16:19], 0
    v_mfma_f32_16x16x32_bf16 v[106:109], v[10:13], v[22:25], v[106:109]
    s_mov_b64 exec, s[42:43]
    ds_write_b128 v4, v[102:105] offset:768
    s_mov_b64 exec, -1
    v_mfma_f32_16x16x32_bf16 v[106:109], v[10:13], v[28:31], v[106:109]
    v_mfma_f32_16x16x32_bf16 v[86:89], v[112:115], v[16:19], 0
    v_mfma_f32_16x16x32_bf16 v[86:89], v[116:119], v[22:25], v[86:89]
    v_mov_b32_dpp v9, v106 quad_perm:[0,1,2,3] row_mask:0x1 bank_mask:0xf
    v_mfma_f32_16x16x32_bf16 v[86:89], v[120:123], v[28:31], v[86:89]
    v_mfma_f32_16x16x32_bf16 v[90:93], v[124:127], v[16:19], 0
    v_mfma_f32_16x16x32_bf16 v[90:93], v[128:131], v[22:25], v[90:93]
    v_cvt_pk_bf16_f32 v74, v86, v87
    v_cvt_pk_bf16_f32 v75, v88, v89
    v_mfma_f32_16x16x32_bf16 v[90:93], v[132:135], v[28:31], v[90:93]
    v_mfma_f32_16x16x32_bf16 v[94:97], v[136:139], v[16:19], 0
    v_mfma_f32_16x16x32_bf16 v[94:97], v[140:143], v[22:25], v[94:97]
    v_cvt_pk_bf16_f32 v76, v90, v91
    v_cvt_pk_bf16_f32 v77, v92, v93
    v_mfma_f32_16x16x32_bf16 v[94:97], v[144:147], v[28:31], v[94:97]
    v_mfma_f32_16x16x32_bf16 v[86:89], v[148:151], v[16:19], 0
    v_mfma_f32_16x16x32_bf16 v[86:89], v[152:155], v[22:25], v[86:89]
    v_cvt_pk_bf16_f32 v78, v94, v95
    v_cvt_pk_bf16_f32 v79, v96, v97
    v_mfma_f32_16x16x32_bf16 v[86:89], v[156:159], v[28:31], v[86:89]
    v_mfma_f32_16x16x32_bf16 v[90:93], v[160:163], v[16:19], 0
    v_mfma_f32_16x16x32_bf16 v[90:93], v[164:167], v[22:25], v[90:93]
    v_cvt_pk_bf16_f32 v80, v86, v87
    v_cvt_pk_bf16_f32 v81, v88, v89
    v_mfma_f32_16x16x32_bf16 v[90:93], v[168:171], v[28:31], v[90:93]
    v_mfma_f32_16x16x32_bf16 v[94:97], v[172:175], v[16:19], 0
    v_mfma_f32_16x16x32_bf16 v[94:97], v[176:179], v[22:25], v[94:97]
    v_cvt_pk_bf16_f32 v82, v90, v91
    v_cvt_pk_bf16_f32 v83, v92, v93
    v_mfma_f32_16x16x32_bf16 v[94:97], v[180:183], v[28:31], v[94:97]
    v_mfma_f32_16x16x32_bf16 v[98:101], v[16:19], v[74:77], 0
    v_mfma_f32_16x16x32_bf16 v[98:101], v[22:25], v[78:81], v[98:101]
    v_cvt_pk_bf16_f32 v84, v94, v95
    v_cvt_pk_bf16_f32 v85, v96, v97
    s_nop 1
    v_mfma_f32_16x16x32_bf16 v[98:101], v[28:31], v[82:85], v[98:101]
    s_mov_b64 exec, s[42:43]
    s_nop 6
    ds_write_b128 v4, v[98:101]
    s_mov_b64 exec, -1
    s_waitcnt lgkmcnt(0)
    s_barrier
    v_mfma_f32_16x16x32_bf16 v[102:105], v[36:39], v[36:39], 0
    v_mfma_f32_16x16x32_bf16 v[102:105], v[42:45], v[42:45], v[102:105]
    v_mfma_f32_16x16x32_bf16 v[102:105], v[48:51], v[48:51], v[102:105]
    v_mfma_f32_16x16x32_bf16 v[106:109], v[10:13], v[36:39], 0
    v_mfma_f32_16x16x32_bf16 v[106:109], v[10:13], v[42:45], v[106:109]
    s_mov_b64 exec, s[42:43]
    ds_write_b128 v4, v[102:105] offset:1024
    s_mov_b64 exec, -1
    v_mfma_f32_16x16x32_bf16 v[106:109], v[10:13], v[48:51], v[106:109]
    v_mfma_f32_16x16x32_bf16 v[86:89], v[112:115], v[36:39], 0
    v_mfma_f32_16x16x32_bf16 v[86:89], v[116:119], v[42:45], v[86:89]
    v_mov_b32_dpp v9, v106 quad_perm:[0,1,2,3] row_mask:0x2 bank_mask:0xf
    v_mfma_f32_16x16x32_bf16 v[86:89], v[120:123], v[48:51], v[86:89]
    v_mfma_f32_16x16x32_bf16 v[90:93], v[124:127], v[36:39], 0
    v_mfma_f32_16x16x32_bf16 v[90:93], v[128:131], v[42:45], v[90:93]
    v_cvt_pk_bf16_f32 v74, v86, v87
    v_cvt_pk_bf16_f32 v75, v88, v89
    v_mfma_f32_16x16x32_bf16 v[90:93], v[132:135], v[48:51], v[90:93]
    v_mfma_f32_16x16x32_bf16 v[94:97], v[136:139], v[36:39], 0
    v_mfma_f32_16x16x32_bf16 v[94:97], v[140:143], v[42:45], v[94:97]
    v_cvt_pk_bf16_f32 v76, v90, v91
    v_cvt_pk_bf16_f32 v77, v92, v93
    v_mfma_f32_16x16x32_bf16 v[94:97], v[144:147], v[48:51], v[94:97]
    v_mfma_f32_16x16x32_bf16 v[86:89], v[148:151], v[36:39], 0
    v_mfma_f32_16x16x32_bf16 v[86:89], v[152:155], v[42:45], v[86:89]
    v_cvt_pk_bf16_f32 v78, v94, v95
    v_cvt_pk_bf16_f32 v79, v96, v97
    v_mfma_f32_16x16x32_bf16 v[86:89], v[156:159], v[48:51], v[86:89]
    v_mfma_f32_16x16x32_bf16 v[90:93], v[160:163], v[36:39], 0
    v_mfma_f32_16x16x32_bf16 v[90:93], v[164:167], v[42:45], v[90:93]
    v_cvt_pk_bf16_f32 v80, v86, v87
    v_cvt_pk_bf16_f32 v81, v88, v89
    v_mfma_f32_16x16x32_bf16 v[90:93], v[168:171], v[48:51], v[90:93]
    v_mfma_f32_16x16x32_bf16 v[94:97], v[172:175], v[36:39], 0
    v_mfma_f32_16x16x32_bf16 v[94:97], v[176:179], v[42:45], v[94:97]
    v_cvt_pk_bf16_f32 v82, v90, v91
    v_cvt_pk_bf16_f32 v83, v92, v93
    v_mfma_f32_16x16x32_bf16 v[94:97], v[180:183], v[48:51], v[94:97]
    v_mfma_f32_16x16x32_bf16 v[98:101], v[36:39], v[74:77], 0
    v_mfma_f32_16x16x32_bf16 v[98:101], v[42:45], v[78:81], v[98:101]
    v_cvt_pk_bf16_f32 v84, v94, v95
    v_cvt_pk_bf16_f32 v85, v96, v97
    v_mfma_f32_16x16x32_bf16 v[102:105], v[56:59], v[56:59], 0
    v_mfma_f32_16x16x32_bf16 v[98:101], v[48:51], v[82:85], v[98:101]
    v_mfma_f32_16x16x32_bf16 v[102:105], v[62:65], v[62:65], v[102:105]
    v_mfma_f32_16x16x32_bf16 v[102:105], v[68:71], v[68:71], v[102:105]
    s_mov_b64 exec, s[42:43]
    ds_write_b128 v4, v[98:101] offset:256
    s_mov_b64 exec, -1
    v_mfma_f32_16x16x32_bf16 v[106:109], v[10:13], v[56:59], 0
    s_mov_b64 exec, s[42:43]
    s_nop 2
    ds_write_b128 v4, v[102:105] offset:1280
    s_mov_b64 exec, -1
    v_mfma_f32_16x16x32_bf16 v[106:109], v[10:13], v[62:65], v[106:109]
    ds_read_b32 v102, v6
    v_mfma_f32_16x16x32_bf16 v[106:109], v[10:13], v[68:71], v[106:109]
    v_mfma_f32_16x16x32_bf16 v[86:89], v[112:115], v[56:59], 0
    v_mfma_f32_16x16x32_bf16 v[86:89], v[116:119], v[62:65], v[86:89]
    v_mov_b32_dpp v9, v106 quad_perm:[0,1,2,3] row_mask:0x4 bank_mask:0xf
    v_mfma_f32_16x16x32_bf16 v[86:89], v[120:123], v[68:71], v[86:89]
    v_mul_f32 v104, v9, v9
    v_mfma_f32_16x16x32_bf16 v[90:93], v[124:127], v[56:59], 0
    v_mfma_f32_16x16x32_bf16 v[90:93], v[128:131], v[62:65], v[90:93]
    v_cvt_pk_bf16_f32 v74, v86, v87
    v_cvt_pk_bf16_f32 v75, v88, v89
    v_mfma_f32_16x16x32_bf16 v[90:93], v[132:135], v[68:71], v[90:93]
    v_mfma_f32_16x16x32_bf16 v[94:97], v[136:139], v[56:59], 0
    s_waitcnt lgkmcnt(0)
    v_fmamk_f32 v102, v104, 0xbc2aaaab, v102
    v_mfma_f32_16x16x32_bf16 v[94:97], v[140:143], v[62:65], v[94:97]
    v_cvt_pk_bf16_f32 v76, v90, v91
    v_cvt_pk_bf16_f32 v77, v92, v93
    v_mfma_f32_16x16x32_bf16 v[94:97], v[144:147], v[68:71], v[94:97]
    v_max_f32 v102, 0, v102
    v_mfma_f32_16x16x32_bf16 v[86:89], v[148:151], v[56:59], 0
    v_add_f32 v102, 0x3a7ba882, v102
    v_mfma_f32_16x16x32_bf16 v[86:89], v[152:155], v[62:65], v[86:89]
    v_cvt_pk_bf16_f32 v78, v94, v95
    v_cvt_pk_bf16_f32 v79, v96, v97
    v_mfma_f32_16x16x32_bf16 v[86:89], v[156:159], v[68:71], v[86:89]
    v_rsq_f32 v103, v102
    v_mfma_f32_16x16x32_bf16 v[90:93], v[160:163], v[56:59], 0
    v_mfma_f32_16x16x32_bf16 v[90:93], v[164:167], v[62:65], v[90:93]
    v_cvt_pk_bf16_f32 v80, v86, v87
    v_cvt_pk_bf16_f32 v81, v88, v89
    v_mfma_f32_16x16x32_bf16 v[90:93], v[168:171], v[68:71], v[90:93]
    v_mfma_f32_16x16x32_bf16 v[94:97], v[172:175], v[56:59], 0
    v_mfma_f32_16x16x32_bf16 v[94:97], v[176:179], v[62:65], v[94:97]
    v_cvt_pk_bf16_f32 v82, v90, v91
    v_cvt_pk_bf16_f32 v83, v92, v93
    v_mfma_f32_16x16x32_bf16 v[94:97], v[180:183], v[68:71], v[94:97]
    v_mfma_f32_16x16x32_bf16 v[98:101], v[56:59], v[74:77], 0
    v_mov_b32 v76, v110
    v_mov_b32 v77, v111
    v_mfma_f32_16x16x32_bf16 v[98:101], v[62:65], v[78:81], v[98:101]
    v_cvt_pk_bf16_f32 v84, v94, v95
    v_cvt_pk_bf16_f32 v85, v96, v97
    v_mfma_f32_16x16x32_bf16 v[86:89], v[16:19], v[184:187], 0
    v_mfma_f32_16x16x32_bf16 v[98:101], v[68:71], v[82:85], v[98:101]
    v_mov_b32 v82, v110
    v_mov_b32 v83, v111
    v_mfma_f32_16x16x32_bf16 v[86:89], v[22:25], v[188:191], v[86:89]
    v_mfma_f32_16x16x32_bf16 v[86:89], v[28:31], v[192:195], v[86:89]
    s_mov_b64 exec, s[42:43]
    ds_write_b128 v4, v[98:101] offset:512
    s_mov_b64 exec, -1
    v_mfma_f32_16x16x32_bf16 v[90:93], v[16:19], v[196:199], 0
    ds_read_b128 v[98:101], v5
    s_nop 2
    v_cvt_pk_bf16_f32 v74, v86, v87
    v_mfma_f32_16x16x32_bf16 v[90:93], v[22:25], v[200:203], v[90:93]
    v_cvt_pk_bf16_f32 v75, v88, v89
    v_mfma_f32_16x16x32_bf16 v[90:93], v[28:31], v[204:207], v[90:93]
    v_mfma_f32_16x16x32_bf16 v[86:89], v[16:19], v[208:211], 0
    v_mfma_f32_16x16x32_bf16 v[86:89], v[22:25], v[212:215], v[86:89]
    v_cvt_pk_bf16_f32 v78, v90, v91
    v_cvt_pk_bf16_f32 v79, v92, v93
    v_mfma_f32_16x16x32_bf16 v[86:89], v[28:31], v[216:219], v[86:89]
    s_nop 7
    v_cvt_pk_bf16_f32 v80, v86, v87
    v_cvt_pk_bf16_f32 v81, v88, v89
    s_waitcnt lgkmcnt(0)
    v_mul_f32_dpp v98, v103, v98 quad_perm:[0,0,0,0] row_mask:0xf bank_mask:0xf
    v_mul_f32_dpp v99, v103, v99 quad_perm:[1,1,1,1] row_mask:0xf bank_mask:0xf
    v_mfma_f32_16x16x32_bf16 v[90:93], v[16:19], v[220:223], 0
    v_mul_f32_dpp v100, v103, v100 quad_perm:[2,2,2,2] row_mask:0xf bank_mask:0xf
    v_mul_f32_dpp v101, v103, v101 quad_perm:[3,3,3,3] row_mask:0xf bank_mask:0xf
    v_mfma_f32_16x16x32_bf16 v[90:93], v[22:25], v[224:227], v[90:93]
    v_max3_f32 v104, v98, v99, v100
    v_mfma_f32_16x16x32_bf16 v[90:93], v[28:31], v[228:231], v[90:93]
    v_max_f32 v104, v104, v101
    v_mul_f32_e64 v104, -v104, v103
    v_fma_f32 v98, v98, v103, v104
    v_fma_f32 v99, v99, v103, v104
    v_fma_f32 v100, v100, v103, v104
    v_fma_f32 v101, v101, v103, v104
    v_mfma_f32_16x16x32_bf16 v[86:89], v[16:19], v[232:235], 0
    v_exp_f32 v98, v98
    v_mfma_f32_16x16x32_bf16 v[86:89], v[22:25], v[236:239], v[86:89]
    v_exp_f32 v99, v99
    v_mfma_f32_16x16x32_bf16 v[86:89], v[28:31], v[240:243], v[86:89]
    v_exp_f32 v100, v100
    v_exp_f32 v101, v101
    v_add_f32 v105, v98, v99
    v_add_f32 v104, v100, v101
    v_mul_f32_dpp v98, v103, v98 quad_perm:[0,0,0,0] row_mask:0xf bank_mask:0xf
    v_add_f32 v105, v105, v104
    v_mul_f32_dpp v99, v103, v99 quad_perm:[1,1,1,1] row_mask:0xf bank_mask:0xf
    v_rcp_f32 v105, v105
    v_mul_f32_dpp v100, v103, v100 quad_perm:[2,2,2,2] row_mask:0xf bank_mask:0xf
    v_mul_f32_dpp v101, v103, v101 quad_perm:[3,3,3,3] row_mask:0xf bank_mask:0xf
    v_mul_f32 v98, v98, v105
    v_mul_f32 v99, v99, v105
    v_mul_f32 v100, v100, v105
    v_mul_f32 v101, v101, v105
    v_cvt_pk_bf16_f32 v102, v98, v99
    v_cvt_pk_bf16_f32 v103, v100, v101
    v_cvt_pk_bf16_f32 v84, v90, v91
    ds_write_b64 v7, v[102:103]
    s_mov_b64 exec, s[42:43]
    ds_read_b64 v[14:15], v8
    ds_read_b64 v[20:21], v8
    ds_read_b64 v[26:27], v8
    ds_read_b64 v[32:33], v8
    s_mov_b64 exec, -1
    v_cvt_pk_bf16_f32 v85, v92, v93
    v_mfma_f32_16x16x32_bf16 v[90:93], v[16:19], v[244:247], 0
    v_mfma_f32_16x16x32_bf16 v[90:93], v[22:25], v[248:251], v[90:93]
    v_mfma_f32_16x16x32_bf16 v[90:93], v[28:31], v[252:255], v[90:93]
    s_waitcnt lgkmcnt(3)
    v_mfma_f32_16x16x32_bf16 v[94:97], v[74:77], v[14:17], 0
    s_mov_b64 exec, s[42:43]
    ds_read_b64 v[34:35], v8 offset:128
    ds_read_b64 v[40:41], v8 offset:128
    ds_read_b64 v[46:47], v8 offset:128
    ds_read_b64 v[52:53], v8 offset:128
    s_mov_b64 exec, -1
    s_waitcnt lgkmcnt(6)
    v_mfma_f32_16x16x32_bf16 v[98:101], v[76:79], v[18:21], 0
    v_cvt_pk_bf16_f32 v74, v86, v87
    v_cvt_pk_bf16_f32 v102, v94, v95
    v_cvt_pk_bf16_f32 v103, v96, v97
    v_mfma_f32_16x16x32_bf16 v[94:97], v[80:83], v[20:23], 0
    v_cvt_pk_bf16_f32 v75, v88, v89
    v_cvt_pk_bf16_f32 v78, v90, v91
    v_mfma_f32_16x16x32_bf16 v[86:89], v[36:39], v[184:187], 0
    v_cvt_pk_bf16_f32 v104, v98, v99
    v_cvt_pk_bf16_f32 v105, v100, v101
    s_waitcnt lgkmcnt(5)
    v_mfma_f32_16x16x32_bf16 v[98:101], v[82:85], v[24:27], 0
    v_cvt_pk_bf16_f32 v106, v94, v95
    v_cvt_pk_bf16_f32 v107, v96, v97
    v_mfma_f32_16x16x32_bf16 v[94:97], v[74:77], v[26:29], 0
    ds_write_b128 v1, v[102:105]
    v_mfma_f32_16x16x32_bf16 v[86:89], v[42:45], v[188:191], v[86:89]
    v_cvt_pk_bf16_f32 v108, v98, v99
    v_cvt_pk_bf16_f32 v109, v100, v101
    v_mfma_f32_16x16x32_bf16 v[86:89], v[48:51], v[192:195], v[86:89]
    ds_write_b128 v1, v[106:109] offset:64
    v_cvt_pk_bf16_f32 v102, v94, v95
    v_cvt_pk_bf16_f32 v103, v96, v97
    v_cvt_pk_bf16_f32 v79, v92, v93
    v_mfma_f32_16x16x32_bf16 v[90:93], v[36:39], v[196:199], 0
    s_nop 2
    v_cvt_pk_bf16_f32 v80, v86, v87
    v_cvt_pk_bf16_f32 v81, v88, v89
    s_waitcnt lgkmcnt(6)
    v_mfma_f32_16x16x32_bf16 v[98:101], v[76:79], v[30:33], 0
    s_waitcnt lgkmcnt(5)
    v_mfma_f32_16x16x32_bf16 v[94:97], v[80:83], v[34:37], 0
    v_mfma_f32_16x16x32_bf16 v[90:93], v[42:45], v[200:203], v[90:93]
    v_cvt_pk_bf16_f32 v104, v98, v99
    v_cvt_pk_bf16_f32 v105, v100, v101
    v_mfma_f32_16x16x32_bf16 v[90:93], v[48:51], v[204:207], v[90:93]
    s_mov_b64 exec, s[42:43]
    ds_read_b64 v[54:55], v8 offset:256
    ds_read_b64 v[60:61], v8 offset:256
    ds_read_b64 v[66:67], v8 offset:256
    ds_read_b64 v[72:73], v8 offset:256
    s_mov_b64 exec, -1
    v_mfma_f32_16x16x32_bf16 v[86:89], v[36:39], v[208:211], 0
    v_cvt_pk_bf16_f32 v106, v94, v95
    v_cvt_pk_bf16_f32 v107, v96, v97
    v_mfma_f32_16x16x32_bf16 v[86:89], v[42:45], v[212:215], v[86:89]
    ds_write_b128 v1, v[102:105] offset:128
    v_mfma_f32_16x16x32_bf16 v[86:89], v[48:51], v[216:219], v[86:89]
    v_cvt_pk_bf16_f32 v84, v90, v91
    v_cvt_pk_bf16_f32 v85, v92, v93
    v_mfma_f32_16x16x32_bf16 v[90:93], v[36:39], v[220:223], 0
    s_waitcnt lgkmcnt(9)
    v_mfma_f32_16x16x32_bf16 v[98:101], v[82:85], v[38:41], 0
    v_cvt_pk_bf16_f32 v74, v86, v87
    v_cvt_pk_bf16_f32 v75, v88, v89
    v_mfma_f32_16x16x32_bf16 v[90:93], v[42:45], v[224:227], v[90:93]
    v_mfma_f32_16x16x32_bf16 v[94:97], v[74:77], v[40:43], 0
    v_cvt_pk_bf16_f32 v108, v98, v99
    v_cvt_pk_bf16_f32 v109, v100, v101
    v_mfma_f32_16x16x32_bf16 v[90:93], v[48:51], v[228:231], v[90:93]
    ds_write_b128 v2, v[106:109]
    v_mfma_f32_16x16x32_bf16 v[86:89], v[36:39], v[232:235], 0
    v_cvt_pk_bf16_f32 v102, v94, v95
    v_cvt_pk_bf16_f32 v103, v96, v97
    v_mfma_f32_16x16x32_bf16 v[86:89], v[42:45], v[236:239], v[86:89]
    v_cvt_pk_bf16_f32 v78, v90, v91
    v_cvt_pk_bf16_f32 v79, v92, v93
    v_mfma_f32_16x16x32_bf16 v[86:89], v[48:51], v[240:243], v[86:89]
    s_waitcnt lgkmcnt(9)
    v_mfma_f32_16x16x32_bf16 v[98:101], v[76:79], v[44:47], 0
    v_mfma_f32_16x16x32_bf16 v[90:93], v[36:39], v[244:247], 0
    v_cvt_pk_bf16_f32 v80, v86, v87
    v_cvt_pk_bf16_f32 v81, v88, v89
    v_mfma_f32_16x16x32_bf16 v[90:93], v[42:45], v[248:251], v[90:93]
    v_cvt_pk_bf16_f32 v104, v98, v99
    v_cvt_pk_bf16_f32 v105, v100, v101
    v_mfma_f32_16x16x32_bf16 v[94:97], v[80:83], v[46:49], 0
    ds_write_b128 v2, v[102:105] offset:64
    v_mfma_f32_16x16x32_bf16 v[90:93], v[48:51], v[252:255], v[90:93]
    s_nop 3
    v_cvt_pk_bf16_f32 v106, v94, v95
    v_mfma_f32_16x16x32_bf16 v[86:89], v[56:59], v[184:187], 0
    v_cvt_pk_bf16_f32 v107, v96, v97
    v_add_u32 v1, s55, v1
    v_mfma_f32_16x16x32_bf16 v[86:89], v[62:65], v[188:191], v[86:89]
    v_cvt_pk_bf16_f32 v84, v90, v91
    v_cvt_pk_bf16_f32 v85, v92, v93
    v_mfma_f32_16x16x32_bf16 v[86:89], v[68:71], v[192:195], v[86:89]
    s_waitcnt lgkmcnt(9)
    v_mfma_f32_16x16x32_bf16 v[98:101], v[82:85], v[50:53], 0
    v_mfma_f32_16x16x32_bf16 v[90:93], v[56:59], v[196:199], 0
    v_cvt_pk_bf16_f32 v74, v86, v87
    v_cvt_pk_bf16_f32 v75, v88, v89
    v_mfma_f32_16x16x32_bf16 v[90:93], v[62:65], v[200:203], v[90:93]
    v_cvt_pk_bf16_f32 v108, v98, v99
    v_cvt_pk_bf16_f32 v109, v100, v101
    s_waitcnt lgkmcnt(6)
    v_mfma_f32_16x16x32_bf16 v[94:97], v[74:77], v[54:57], 0
    ds_write_b128 v2, v[106:109] offset:128
    v_mfma_f32_16x16x32_bf16 v[90:93], v[68:71], v[204:207], v[90:93]
    v_add_u32 v2, s55, v2
    s_nop 1
    v_cvt_pk_bf16_f32 v102, v94, v95
    v_mfma_f32_16x16x32_bf16 v[86:89], v[56:59], v[208:211], 0
    v_cvt_pk_bf16_f32 v103, v96, v97
    v_mfma_f32_16x16x32_bf16 v[86:89], v[62:65], v[212:215], v[86:89]
    v_cvt_pk_bf16_f32 v78, v90, v91
    v_cvt_pk_bf16_f32 v79, v92, v93
    v_mfma_f32_16x16x32_bf16 v[86:89], v[68:71], v[216:219], v[86:89]
    s_waitcnt lgkmcnt(6)
    v_mfma_f32_16x16x32_bf16 v[98:101], v[76:79], v[58:61], 0
    v_mfma_f32_16x16x32_bf16 v[90:93], v[56:59], v[220:223], 0
    v_cvt_pk_bf16_f32 v80, v86, v87
    v_cvt_pk_bf16_f32 v81, v88, v89
    v_mfma_f32_16x16x32_bf16 v[90:93], v[62:65], v[224:227], v[90:93]
    v_cvt_pk_bf16_f32 v104, v98, v99
    v_cvt_pk_bf16_f32 v105, v100, v101
    v_mfma_f32_16x16x32_bf16 v[94:97], v[80:83], v[60:63], 0
    ds_write_b128 v3, v[102:105]
    v_mfma_f32_16x16x32_bf16 v[90:93], v[68:71], v[228:231], v[90:93]
    s_nop 3
    v_cvt_pk_bf16_f32 v106, v94, v95
    v_mfma_f32_16x16x32_bf16 v[86:89], v[56:59], v[232:235], 0
    v_cvt_pk_bf16_f32 v107, v96, v97
    v_mfma_f32_16x16x32_bf16 v[86:89], v[62:65], v[236:239], v[86:89]
    v_cvt_pk_bf16_f32 v84, v90, v91
    v_cvt_pk_bf16_f32 v85, v92, v93
    v_mfma_f32_16x16x32_bf16 v[86:89], v[68:71], v[240:243], v[86:89]
    s_waitcnt lgkmcnt(6)
    v_mfma_f32_16x16x32_bf16 v[98:101], v[82:85], v[64:67], 0
    v_mfma_f32_16x16x32_bf16 v[90:93], v[56:59], v[244:247], 0
    v_cvt_pk_bf16_f32 v74, v86, v87
    v_cvt_pk_bf16_f32 v75, v88, v89
    v_mfma_f32_16x16x32_bf16 v[90:93], v[62:65], v[248:251], v[90:93]
    v_cvt_pk_bf16_f32 v108, v98, v99
    v_cvt_pk_bf16_f32 v109, v100, v101
    v_mfma_f32_16x16x32_bf16 v[94:97], v[74:77], v[66:69], 0
    ds_write_b128 v3, v[106:109] offset:64
    v_mfma_f32_16x16x32_bf16 v[90:93], v[68:71], v[252:255], v[90:93]
    s_nop 3
    v_cvt_pk_bf16_f32 v102, v94, v95
    v_cvt_pk_bf16_f32 v103, v96, v97
    s_nop 1
    v_cvt_pk_bf16_f32 v78, v90, v91
    v_cvt_pk_bf16_f32 v79, v92, v93
    s_waitcnt lgkmcnt(6)
    s_nop 0
    v_mfma_f32_16x16x32_bf16 v[98:101], v[76:79], v[70:73], 0
    s_nop 7
    v_cvt_pk_bf16_f32 v104, v98, v99
    v_cvt_pk_bf16_f32 v105, v100, v101
    ds_write_b128 v3, v[102:105] offset:128
    v_add_u32 v3, s55, v3
    s_sub_u32 s55, 0, s55
    s_add_u32 s39, s39, 1
    s_waitcnt lgkmcnt(0)
    s_barrier
L_Tloop:
    ds_read_b128 v[16:19], v1
    ds_read_b128 v[22:25], v1 offset:64
    ds_read_b128 v[48:51], v2 offset:128
    ds_read_b128 v[28:31], v1 offset:128
    ds_read_b128 v[56:59], v3
    s_setprio 0
    s_waitcnt lgkmcnt(4)
    v_mfma_f32_16x16x32_bf16 v[94:97], v[136:139], v[16:19], 0
    v_mfma_f32_16x16x32_bf16 v[86:89], v[112:115], v[16:19], 0
    ds_read_b128 v[42:45], v2 offset:64
    v_mfma_f32_16x16x32_bf16 v[102:105], v[16:19], v[16:19], 0
    ds_read_b128 v[36:39], v2
    s_waitcnt lgkmcnt(5)
    v_mfma_f32_16x16x32_bf16 v[86:89], v[116:119], v[22:25], v[86:89]
    s_waitcnt lgkmcnt(3)
    v_mfma_f32_16x16x32_bf16 v[86:89], v[120:123], v[28:31], v[86:89]
    v_mfma_f32_16x16x32_bf16 v[90:93], v[124:127], v[16:19], 0
    v_mfma_f32_16x16x32_bf16 v[106:109], v[10:13], v[16:19], 0
    v_mfma_f32_16x16x32_bf16 v[106:109], v[10:13], v[22:25], v[106:109]
    v_mfma_f32_16x16x32_bf16 v[106:109], v[10:13], v[28:31], v[106:109]
    s_setprio 3
    v_cvt_pk_bf16_f32 v75, v88, v89
    s_setprio 0
    v_mfma_f32_16x16x32_bf16 v[90:93], v[128:131], v[22:25], v[90:93]
    v_mfma_f32_16x16x32_bf16 v[90:93], v[132:135], v[28:31], v[90:93]
    s_setprio 3
    v_cvt_pk_bf16_f32 v74, v86, v87
    s_setprio 0
    v_mfma_f32_16x16x32_bf16 v[102:105], v[22:25], v[22:25], v[102:105]
    v_mfma_f32_16x16x32_bf16 v[94:97], v[140:143], v[22:25], v[94:97]
    v_mfma_f32_16x16x32_bf16 v[86:89], v[148:151], v[16:19], 0
    s_setprio 3
    v_cvt_pk_bf16_f32 v77, v92, v93
    s_setprio 0
    v_mfma_f32_16x16x32_bf16 v[94:97], v[144:147], v[28:31], v[94:97]
    v_mfma_f32_16x16x32_bf16 v[86:89], v[152:155], v[22:25], v[86:89]
    v_mfma_f32_16x16x32_bf16 v[86:89], v[156:159], v[28:31], v[86:89]
    s_setprio 3
    v_cvt_pk_bf16_f32 v76, v90, v91
    s_setprio 0
    v_mfma_f32_16x16x32_bf16 v[90:93], v[160:163], v[16:19], 0
    v_mfma_f32_16x16x32_bf16 v[90:93], v[164:167], v[22:25], v[90:93]
    s_setprio 3
    v_cvt_pk_bf16_f32 v81, v88, v89
    s_setprio 0
    v_mfma_f32_16x16x32_bf16 v[90:93], v[168:171], v[28:31], v[90:93]
    s_setprio 3
    v_cvt_pk_bf16_f32 v80, v86, v87
    s_setprio 0
    v_mfma_f32_16x16x32_bf16 v[98:101], v[16:19], v[74:77], 0
    ds_read_b128 v[62:65], v3 offset:64
    v_mfma_f32_16x16x32_bf16 v[102:105], v[28:31], v[28:31], v[102:105]
    s_waitcnt lgkmcnt(1)
    v_mfma_f32_16x16x32_bf16 v[86:89], v[112:115], v[36:39], 0
    s_setprio 3
    v_cvt_pk_bf16_f32 v78, v94, v95
    v_cvt_pk_bf16_f32 v79, v96, v97
    s_setprio 0
    v_mfma_f32_16x16x32_bf16 v[94:97], v[172:175], v[16:19], 0
    v_mfma_f32_16x16x32_bf16 v[94:97], v[176:179], v[22:25], v[94:97]
    v_mfma_f32_16x16x32_bf16 v[94:97], v[180:183], v[28:31], v[94:97]
    v_mfma_f32_16x16x32_bf16 v[86:89], v[116:119], v[42:45], v[86:89]
    s_setprio 3
    v_mov_b32_dpp v9, v106 quad_perm:[0,1,2,3] row_mask:0x1 bank_mask:0xf
    v_cvt_pk_bf16_f32 v82, v90, v91
    s_setprio 0
    v_mfma_f32_16x16x32_bf16 v[86:89], v[120:123], v[48:51], v[86:89]
    s_setprio 3
    v_cvt_pk_bf16_f32 v83, v92, v93
    v_cvt_pk_bf16_f32 v84, v94, v95
    s_setprio 0
    v_mfma_f32_16x16x32_bf16 v[90:93], v[124:127], v[36:39], 0
    s_setprio 3
    v_cvt_pk_bf16_f32 v85, v96, v97
    s_setprio 0
    v_mfma_f32_16x16x32_bf16 v[94:97], v[136:139], v[36:39], 0
    v_mfma_f32_16x16x32_bf16 v[94:97], v[140:143], v[42:45], v[94:97]
    ds_read_b128 v[68:71], v3 offset:128
    v_mfma_f32_16x16x32_bf16 v[98:101], v[22:25], v[78:81], v[98:101]
    v_mfma_f32_16x16x32_bf16 v[94:97], v[144:147], v[48:51], v[94:97]
    s_setprio 3
    v_cvt_pk_bf16_f32 v75, v88, v89
    v_cvt_pk_bf16_f32 v74, v86, v87
    s_setprio 0
    v_mfma_f32_16x16x32_bf16 v[90:93], v[128:131], v[42:45], v[90:93]
    v_mfma_f32_16x16x32_bf16 v[90:93], v[132:135], v[48:51], v[90:93]
    s_mov_b64 exec, s[42:43]
    ds_write_b128 v4, v[102:105] offset:768
    s_mov_b64 exec, -1
    v_mfma_f32_16x16x32_bf16 v[86:89], v[148:151], v[36:39], 0
    v_mfma_f32_16x16x32_bf16 v[102:105], v[36:39], v[36:39], 0
    v_mfma_f32_16x16x32_bf16 v[102:105], v[42:45], v[42:45], v[102:105]
    v_mfma_f32_16x16x32_bf16 v[86:89], v[152:155], v[42:45], v[86:89]
    v_mfma_f32_16x16x32_bf16 v[86:89], v[156:159], v[48:51], v[86:89]
    s_setprio 3
    v_cvt_pk_bf16_f32 v78, v94, v95
    v_cvt_pk_bf16_f32 v79, v96, v97
    s_setprio 0
    v_mfma_f32_16x16x32_bf16 v[94:97], v[172:175], v[36:39], 0
    s_setprio 3
    v_cvt_pk_bf16_f32 v76, v90, v91
    s_setprio 0
    v_mfma_f32_16x16x32_bf16 v[102:105], v[48:51], v[48:51], v[102:105]
    v_mfma_f32_16x16x32_bf16 v[94:97], v[176:179], v[42:45], v[94:97]
    s_setprio 3
    v_cvt_pk_bf16_f32 v77, v92, v93
    s_setprio 0
    v_mfma_f32_16x16x32_bf16 v[90:93], v[160:163], v[36:39], 0
    v_mfma_f32_16x16x32_bf16 v[90:93], v[164:167], v[42:45], v[90:93]
    s_mov_b64 exec, s[42:43]
    ds_write_b128 v4, v[102:105] offset:1024
    s_mov_b64 exec, -1
    v_mfma_f32_16x16x32_bf16 v[102:105], v[56:59], v[56:59], 0
    v_mfma_f32_16x16x32_bf16 v[98:101], v[28:31], v[82:85], v[98:101]
    v_mfma_f32_16x16x32_bf16 v[94:97], v[180:183], v[48:51], v[94:97]
    s_waitcnt lgkmcnt(3)
    v_mfma_f32_16x16x32_bf16 v[102:105], v[62:65], v[62:65], v[102:105]
    s_mov_b64 exec, s[42:43]
    ds_write_b128 v4, v[98:101]
    s_mov_b64 exec, -1
    v_mfma_f32_16x16x32_bf16 v[90:93], v[168:171], v[48:51], v[90:93]
    s_setprio 3
    v_cvt_pk_bf16_f32 v84, v94, v95
    s_setprio 0
    s_waitcnt lgkmcnt(3)
    v_mfma_f32_16x16x32_bf16 v[102:105], v[68:71], v[68:71], v[102:105]
    s_setprio 3
    v_cvt_pk_bf16_f32 v81, v88, v89
    s_setprio 0
    v_mfma_f32_16x16x32_bf16 v[98:101], v[36:39], v[74:77], 0
    s_setprio 3
    v_cvt_pk_bf16_f32 v80, v86, v87
    s_setprio 0
    v_mfma_f32_16x16x32_bf16 v[86:89], v[112:115], v[56:59], 0
    v_mfma_f32_16x16x32_bf16 v[86:89], v[116:119], v[62:65], v[86:89]
    s_setprio 3
    v_cvt_pk_bf16_f32 v82, v90, v91
    s_setprio 0
    v_mfma_f32_16x16x32_bf16 v[98:101], v[42:45], v[78:81], v[98:101]
    s_setprio 3
    v_cvt_pk_bf16_f32 v83, v92, v93
    v_cvt_pk_bf16_f32 v85, v96, v97
    s_setprio 0
    v_mfma_f32_16x16x32_bf16 v[94:97], v[136:139], v[56:59], 0
    v_mfma_f32_16x16x32_bf16 v[94:97], v[140:143], v[62:65], v[94:97]
    v_mfma_f32_16x16x32_bf16 v[94:97], v[144:147], v[68:71], v[94:97]
    v_mfma_f32_16x16x32_bf16 v[86:89], v[120:123], v[68:71], v[86:89]
    v_mfma_f32_16x16x32_bf16 v[98:101], v[48:51], v[82:85], v[98:101]
    v_mfma_f32_16x16x32_bf16 v[90:93], v[124:127], v[56:59], 0
    s_setprio 3
    v_cvt_pk_bf16_f32 v74, v86, v87
    v_cvt_pk_bf16_f32 v75, v88, v89
    s_setprio 0
    v_mfma_f32_16x16x32_bf16 v[90:93], v[128:131], v[62:65], v[90:93]
    s_setprio 3
    v_cvt_pk_bf16_f32 v78, v94, v95
    s_setprio 0
    v_mfma_f32_16x16x32_bf16 v[86:89], v[148:151], v[56:59], 0
    s_setprio 3
    v_cvt_pk_bf16_f32 v79, v96, v97
    s_setprio 0
    v_mfma_f32_16x16x32_bf16 v[86:89], v[152:155], v[62:65], v[86:89]
    v_mfma_f32_16x16x32_bf16 v[90:93], v[132:135], v[68:71], v[90:93]
    s_mov_b64 exec, s[42:43]
    ds_write_b128 v4, v[98:101] offset:256
    s_mov_b64 exec, -1
    v_mfma_f32_16x16x32_bf16 v[94:97], v[172:175], v[56:59], 0
    v_mfma_f32_16x16x32_bf16 v[94:97], v[176:179], v[62:65], v[94:97]
    v_mfma_f32_16x16x32_bf16 v[94:97], v[180:183], v[68:71], v[94:97]
    s_mov_b64 exec, s[42:43]
    ds_write_b128 v4, v[102:105] offset:1280
    s_mov_b64 exec, -1
    v_mfma_f32_16x16x32_bf16 v[86:89], v[156:159], v[68:71], v[86:89]
    s_setprio 3
    v_cvt_pk_bf16_f32 v77, v92, v93
    v_cvt_pk_bf16_f32 v76, v90, v91
    s_setprio 0
    v_mfma_f32_16x16x32_bf16 v[90:93], v[160:163], v[56:59], 0
    ds_read_b32 v102, v6
    s_setprio 3
    v_cvt_pk_bf16_f32 v84, v94, v95
    s_setprio 0
    v_mfma_f32_16x16x32_bf16 v[90:93], v[164:167], v[62:65], v[90:93]
    s_setprio 3
    v_cvt_pk_bf16_f32 v85, v96, v97
    s_setprio 0
    v_mfma_f32_16x16x32_bf16 v[90:93], v[168:171], v[68:71], v[90:93]
    s_setprio 3
    v_cvt_pk_bf16_f32 v80, v86, v87
    s_setprio 0
    v_mfma_f32_16x16x32_bf16 v[106:109], v[10:13], v[36:39], 0
    s_setprio 3
    v_cvt_pk_bf16_f32 v81, v88, v89
    s_setprio 0
    v_mfma_f32_16x16x32_bf16 v[98:101], v[56:59], v[74:77], 0
    s_setprio 3
    v_cvt_pk_bf16_f32 v82, v90, v91
    v_cvt_pk_bf16_f32 v83, v92, v93
    s_setprio 0
    v_mfma_f32_16x16x32_bf16 v[98:101], v[62:65], v[78:81], v[98:101]
    v_mfma_f32_16x16x32_bf16 v[98:101], v[68:71], v[82:85], v[98:101]
    s_setprio 3
    v_mov_b32 v82, v110
    v_mov_b32 v76, v110
    s_setprio 0
    v_mfma_f32_16x16x32_bf16 v[90:93], v[16:19], v[196:199], 0
    v_mfma_f32_16x16x32_bf16 v[106:109], v[10:13], v[42:45], v[106:109]
    s_mov_b64 exec, s[42:43]
    ds_write_b128 v4, v[98:101] offset:512
    s_mov_b64 exec, -1
    v_mfma_f32_16x16x32_bf16 v[106:109], v[10:13], v[48:51], v[106:109]
    ds_read_b128 v[98:101], v5
    v_mfma_f32_16x16x32_bf16 v[90:93], v[22:25], v[200:203], v[90:93]
    v_mfma_f32_16x16x32_bf16 v[90:93], v[28:31], v[204:207], v[90:93]
    s_setprio 3
    v_mov_b32_dpp v9, v106 quad_perm:[0,1,2,3] row_mask:0x2 bank_mask:0xf
    s_setprio 0
    v_mfma_f32_16x16x32_bf16 v[106:109], v[10:13], v[56:59], 0
    s_setprio 3
    v_mov_b32 v77, v111
    s_setprio 0
    v_mfma_f32_16x16x32_bf16 v[106:109], v[10:13], v[62:65], v[106:109]
    v_mfma_f32_16x16x32_bf16 v[106:109], v[10:13], v[68:71], v[106:109]
    s_setprio 3
    v_cvt_pk_bf16_f32 v78, v90, v91
    v_cvt_pk_bf16_f32 v79, v92, v93
    s_setprio 0
    v_mfma_f32_16x16x32_bf16 v[86:89], v[16:19], v[184:187], 0
    v_mfma_f32_16x16x32_bf16 v[86:89], v[22:25], v[188:191], v[86:89]
    s_setprio 3
    v_mov_b32_dpp v9, v106 quad_perm:[0,1,2,3] row_mask:0x4 bank_mask:0xf
    v_mul_f32 v104, v9, v9
    s_setprio 0
    v_mfma_f32_16x16x32_bf16 v[86:89], v[28:31], v[192:195], v[86:89]
    s_setprio 3
    s_waitcnt lgkmcnt(2)
    v_fmamk_f32 v102, v104, 0xbc2aaaab, v102
    v_max_f32 v102, 0, v102
    s_setprio 0
    v_mfma_f32_16x16x32_bf16 v[90:93], v[16:19], v[220:223], 0
    s_setprio 3
    v_add_f32 v102, 0x3a7ba882, v102
    v_rsq_f32 v103, v102
    s_setprio 0
    v_mfma_f32_16x16x32_bf16 v[90:93], v[22:25], v[224:227], v[90:93]
    s_setprio 3
    v_cvt_pk_bf16_f32 v75, v88, v89
    v_cvt_pk_bf16_f32 v74, v86, v87
    s_setprio 0
    v_mfma_f32_16x16x32_bf16 v[86:89], v[16:19], v[208:211], 0
    s_setprio 3
    s_waitcnt lgkmcnt(0)
    v_mul_f32_dpp v98, v103, v98 quad_perm:[0,0,0,0] row_mask:0xf bank_mask:0xf
    v_mul_f32_dpp v100, v103, v100 quad_perm:[2,2,2,2] row_mask:0xf bank_mask:0xf
    s_setprio 0
    v_mfma_f32_16x16x32_bf16 v[90:93], v[28:31], v[228:231], v[90:93]
    s_setprio 3
    v_mul_f32_dpp v99, v103, v99 quad_perm:[1,1,1,1] row_mask:0xf bank_mask:0xf
    v_max3_f32 v104, v98, v99, v100
    v_mul_f32_dpp v101, v103, v101 quad_perm:[3,3,3,3] row_mask:0xf bank_mask:0xf
    v_max_f32 v104, v104, v101
    v_mul_f32_e64 v104, -v104, v103
    v_fma_f32 v99, v99, v103, v104
    v_exp_f32 v99, v99
    v_fma_f32 v98, v98, v103, v104
    v_fma_f32 v101, v101, v103, v104
    v_fma_f32 v100, v100, v103, v104
    v_exp_f32 v100, v100
    v_exp_f32 v101, v101
    v_exp_f32 v98, v98
    v_add_f32 v104, v100, v101
    v_mul_f32_dpp v100, v103, v100 quad_perm:[2,2,2,2] row_mask:0xf bank_mask:0xf
    v_add_f32 v105, v98, v99
    v_add_f32 v105, v105, v104
    v_rcp_f32 v105, v105
    v_mul_f32_dpp v101, v103, v101 quad_perm:[3,3,3,3] row_mask:0xf bank_mask:0xf
    v_mul_f32_dpp v99, v103, v99 quad_perm:[1,1,1,1] row_mask:0xf bank_mask:0xf
    v_mul_f32_dpp v98, v103, v98 quad_perm:[0,0,0,0] row_mask:0xf bank_mask:0xf
    v_mul_f32 v98, v98, v105
    v_mul_f32 v99, v99, v105
    s_setprio 0
    v_mfma_f32_16x16x32_bf16 v[86:89], v[22:25], v[212:215], v[86:89]
    s_setprio 3
    v_cvt_pk_bf16_f32 v102, v98, v99
    v_mul_f32 v101, v101, v105
    v_mul_f32 v100, v100, v105
    v_cvt_pk_bf16_f32 v103, v100, v101
    s_setprio 0
    v_mfma_f32_16x16x32_bf16 v[86:89], v[28:31], v[216:219], v[86:89]
    ds_write_b64 v7, v[102:103]
    s_setprio 3
    v_cvt_pk_bf16_f32 v85, v92, v93
    v_cvt_pk_bf16_f32 v84, v90, v91
    s_setprio 0
    v_mfma_f32_16x16x32_bf16 v[90:93], v[16:19], v[244:247], 0
    s_mov_b64 exec, s[42:43]
    ds_read_b64 v[14:15], v8
    ds_read_b64 v[20:21], v8
    ds_read_b64 v[26:27], v8
    ds_read_b64 v[32:33], v8
    s_mov_b64 exec, -1
    v_mfma_f32_16x16x32_bf16 v[90:93], v[22:25], v[248:251], v[90:93]
    s_setprio 3
    v_cvt_pk_bf16_f32 v81, v88, v89
    v_cvt_pk_bf16_f32 v80, v86, v87
    s_setprio 0
    v_mfma_f32_16x16x32_bf16 v[86:89], v[16:19], v[232:235], 0
    v_mfma_f32_16x16x32_bf16 v[86:89], v[22:25], v[236:239], v[86:89]
    s_mov_b64 exec, s[42:43]
    ds_read_b64 v[54:55], v8 offset:256
    ds_read_b64 v[60:61], v8 offset:256
    ds_read_b64 v[66:67], v8 offset:256
    ds_read_b64 v[72:73], v8 offset:256
    s_mov_b64 exec, -1
    v_mfma_f32_16x16x32_bf16 v[86:89], v[28:31], v[240:243], v[86:89]
    s_mov_b64 exec, s[42:43]
    ds_read_b64 v[34:35], v8 offset:128
    ds_read_b64 v[40:41], v8 offset:128
    ds_read_b64 v[46:47], v8 offset:128
    ds_read_b64 v[52:53], v8 offset:128
    s_mov_b64 exec, -1
    v_mfma_f32_16x16x32_bf16 v[90:93], v[28:31], v[252:255], v[90:93]
    s_waitcnt lgkmcnt(11)
    v_mfma_f32_16x16x32_bf16 v[94:97], v[74:77], v[14:17], 0
    s_setprio 3
    v_cvt_pk_bf16_f32 v75, v88, v89
    s_setprio 0
    s_waitcnt lgkmcnt(10)
    v_mfma_f32_16x16x32_bf16 v[98:101], v[76:79], v[18:21], 0
    s_setprio 3
    v_cvt_pk_bf16_f32 v78, v90, v91
    v_cvt_pk_bf16_f32 v79, v92, v93
    s_setprio 0
    v_mfma_f32_16x16x32_bf16 v[90:93], v[36:39], v[196:199], 0
    v_mfma_f32_16x16x32_bf16 v[90:93], v[42:45], v[200:203], v[90:93]
    s_setprio 3
    v_mov_b32 v83, v111
    v_cvt_pk_bf16_f32 v104, v98, v99
    s_setprio 0
    v_mfma_f32_16x16x32_bf16 v[90:93], v[48:51], v[204:207], v[90:93]
    s_setprio 3
    v_cvt_pk_bf16_f32 v103, v96, v97
    v_cvt_pk_bf16_f32 v102, v94, v95
    s_setprio 0
    v_mfma_f32_16x16x32_bf16 v[94:97], v[80:83], v[20:23], 0
    s_setprio 3
    v_cvt_pk_bf16_f32 v74, v86, v87
    s_setprio 0
    v_mfma_f32_16x16x32_bf16 v[86:89], v[36:39], v[184:187], 0
    v_mfma_f32_16x16x32_bf16 v[86:89], v[42:45], v[188:191], v[86:89]
    s_setprio 3
    v_cvt_pk_bf16_f32 v105, v100, v101
    s_setprio 0
    s_waitcnt lgkmcnt(9)
    v_mfma_f32_16x16x32_bf16 v[98:101], v[82:85], v[24:27], 0
    s_setprio 3
    v_cvt_pk_bf16_f32 v84, v90, v91
    v_cvt_pk_bf16_f32 v85, v92, v93
    s_setprio 0
    v_mfma_f32_16x16x32_bf16 v[90:93], v[36:39], v[220:223], 0
    v_mfma_f32_16x16x32_bf16 v[90:93], v[42:45], v[224:227], v[90:93]
    v_mfma_f32_16x16x32_bf16 v[86:89], v[48:51], v[192:195], v[86:89]
    s_setprio 3
    v_cvt_pk_bf16_f32 v107, v96, v97
    v_cvt_pk_bf16_f32 v106, v94, v95
    s_setprio 0
    v_mfma_f32_16x16x32_bf16 v[94:97], v[74:77], v[26:29], 0
    s_setprio 3
    v_cvt_pk_bf16_f32 v108, v98, v99
    v_cvt_pk_bf16_f32 v109, v100, v101
    s_setprio 0
    v_mfma_f32_16x16x32_bf16 v[90:93], v[48:51], v[228:231], v[90:93]
    s_setprio 3
    v_cvt_pk_bf16_f32 v80, v86, v87
    s_setprio 0
    s_waitcnt lgkmcnt(8)
    v_mfma_f32_16x16x32_bf16 v[98:101], v[76:79], v[30:33], 0
    s_setprio 3
    v_cvt_pk_bf16_f32 v81, v88, v89
    s_setprio 0
    v_mfma_f32_16x16x32_bf16 v[86:89], v[36:39], v[208:211], 0
    s_setprio 3
    v_cvt_pk_bf16_f32 v79, v92, v93
    s_setprio 0
    v_mfma_f32_16x16x32_bf16 v[86:89], v[42:45], v[212:215], v[86:89]
    ds_write_b128 v1, v[102:105]
    v_mfma_f32_16x16x32_bf16 v[86:89], v[48:51], v[216:219], v[86:89]
    s_setprio 3
    v_cvt_pk_bf16_f32 v78, v90, v91
    s_setprio 0
    v_mfma_f32_16x16x32_bf16 v[90:93], v[36:39], v[244:247], 0
    ds_write_b128 v1, v[106:109] offset:64
    v_mfma_f32_16x16x32_bf16 v[90:93], v[42:45], v[248:251], v[90:93]
    s_setprio 3
    v_cvt_pk_bf16_f32 v74, v86, v87
    v_cvt_pk_bf16_f32 v104, v98, v99
    s_setprio 0
    v_mfma_f32_16x16x32_bf16 v[90:93], v[48:51], v[252:255], v[90:93]
    s_setprio 3
    v_cvt_pk_bf16_f32 v75, v88, v89
    s_setprio 0
    v_mfma_f32_16x16x32_bf16 v[86:89], v[36:39], v[232:235], 0
    v_mfma_f32_16x16x32_bf16 v[86:89], v[42:45], v[236:239], v[86:89]
    s_setprio 3
    v_cvt_pk_bf16_f32 v105, v100, v101
    s_setprio 0
    v_mfma_f32_16x16x32_bf16 v[86:89], v[48:51], v[240:243], v[86:89]
    s_setprio 3
    v_cvt_pk_bf16_f32 v103, v96, v97
    s_setprio 0
    s_waitcnt lgkmcnt(4)
    v_mfma_f32_16x16x32_bf16 v[98:101], v[82:85], v[38:41], 0
    s_setprio 3
    v_cvt_pk_bf16_f32 v85, v92, v93
    v_cvt_pk_bf16_f32 v102, v94, v95
    s_setprio 0
    v_mfma_f32_16x16x32_bf16 v[94:97], v[80:83], v[34:37], 0
    s_setprio 3
    v_cvt_pk_bf16_f32 v80, v86, v87
    v_cvt_pk_bf16_f32 v81, v88, v89
    s_setprio 0
    v_mfma_f32_16x16x32_bf16 v[86:89], v[56:59], v[184:187], 0
    v_mfma_f32_16x16x32_bf16 v[86:89], v[62:65], v[188:191], v[86:89]
    s_setprio 3
    v_cvt_pk_bf16_f32 v106, v94, v95
    v_cvt_pk_bf16_f32 v109, v100, v101
    s_setprio 0
    v_mfma_f32_16x16x32_bf16 v[86:89], v[68:71], v[192:195], v[86:89]
    s_setprio 3
    v_cvt_pk_bf16_f32 v84, v90, v91
    v_cvt_pk_bf16_f32 v107, v96, v97
    s_setprio 0
    v_mfma_f32_16x16x32_bf16 v[94:97], v[74:77], v[40:43], 0
    s_setprio 3
    v_cvt_pk_bf16_f32 v108, v98, v99
    s_setprio 0
    s_waitcnt lgkmcnt(3)
    v_mfma_f32_16x16x32_bf16 v[98:101], v[76:79], v[44:47], 0
    s_setprio 3
    v_cvt_pk_bf16_f32 v74, v86, v87
    v_cvt_pk_bf16_f32 v75, v88, v89
    s_setprio 0
    v_mfma_f32_16x16x32_bf16 v[86:89], v[56:59], v[208:211], 0
    ds_write_b128 v1, v[102:105] offset:128
    v_mfma_f32_16x16x32_bf16 v[90:93], v[56:59], v[196:199], 0
    s_setprio 3
    v_cvt_pk_bf16_f32 v103, v96, v97
    v_cvt_pk_bf16_f32 v104, v98, v99
    s_setprio 0
    v_mfma_f32_16x16x32_bf16 v[90:93], v[62:65], v[200:203], v[90:93]
    s_setprio 3
    v_cvt_pk_bf16_f32 v105, v100, v101
    s_setprio 0
    s_waitcnt lgkmcnt(3)
    v_mfma_f32_16x16x32_bf16 v[98:101], v[82:85], v[50:53], 0
    s_setprio 3
    v_cvt_pk_bf16_f32 v102, v94, v95
    s_setprio 0
    v_mfma_f32_16x16x32_bf16 v[94:97], v[80:83], v[46:49], 0
    ds_write_b128 v2, v[106:109]
    v_mfma_f32_16x16x32_bf16 v[90:93], v[68:71], v[204:207], v[90:93]
    s_setprio 3
    v_add_u32 v1, s55, v1
    v_cvt_pk_bf16_f32 v109, v100, v101
    s_setprio 0
    v_mfma_f32_16x16x32_bf16 v[86:89], v[62:65], v[212:215], v[86:89]
    v_mfma_f32_16x16x32_bf16 v[86:89], v[68:71], v[216:219], v[86:89]
    s_setprio 3
    v_cvt_pk_bf16_f32 v107, v96, v97
    v_cvt_pk_bf16_f32 v106, v94, v95
    s_setprio 0
    v_mfma_f32_16x16x32_bf16 v[94:97], v[74:77], v[54:57], 0
    s_setprio 3
    v_cvt_pk_bf16_f32 v78, v90, v91
    v_cvt_pk_bf16_f32 v79, v92, v93
    s_setprio 0
    v_mfma_f32_16x16x32_bf16 v[90:93], v[56:59], v[220:223], 0
    v_mfma_f32_16x16x32_bf16 v[90:93], v[62:65], v[224:227], v[90:93]
    s_setprio 3
    v_cvt_pk_bf16_f32 v80, v86, v87
    v_cvt_pk_bf16_f32 v81, v88, v89
    s_setprio 0
    v_mfma_f32_16x16x32_bf16 v[90:93], v[68:71], v[228:231], v[90:93]
    s_setprio 3
    v_cvt_pk_bf16_f32 v108, v98, v99
    s_setprio 0
    v_mfma_f32_16x16x32_bf16 v[98:101], v[76:79], v[58:61], 0
    ds_write_b128 v2, v[102:105] offset:64
    v_mfma_f32_16x16x32_bf16 v[86:89], v[56:59], v[232:235], 0
    s_setprio 3
    v_cvt_pk_bf16_f32 v84, v90, v91
    s_setprio 0
    v_mfma_f32_16x16x32_bf16 v[86:89], v[62:65], v[236:239], v[86:89]
    s_setprio 3
    v_cvt_pk_bf16_f32 v104, v98, v99
    s_setprio 0
    v_mfma_f32_16x16x32_bf16 v[86:89], v[68:71], v[240:243], v[86:89]
    s_setprio 3
    v_cvt_pk_bf16_f32 v103, v96, v97
    v_cvt_pk_bf16_f32 v102, v94, v95
    s_setprio 0
    v_mfma_f32_16x16x32_bf16 v[94:97], v[80:83], v[60:63], 0
    s_setprio 3
    v_cvt_pk_bf16_f32 v85, v92, v93
    v_cvt_pk_bf16_f32 v105, v100, v101
    s_setprio 0
    v_mfma_f32_16x16x32_bf16 v[90:93], v[56:59], v[244:247], 0
    ds_write_b128 v3, v[102:105]
    v_mfma_f32_16x16x32_bf16 v[90:93], v[62:65], v[248:251], v[90:93]
    ds_write_b128 v2, v[106:109] offset:128
    v_mfma_f32_16x16x32_bf16 v[90:93], v[68:71], v[252:255], v[90:93]
    s_setprio 3
    v_cvt_pk_bf16_f32 v107, v96, v97
    v_cvt_pk_bf16_f32 v75, v88, v89
    s_setprio 0
    v_mfma_f32_16x16x32_bf16 v[98:101], v[82:85], v[64:67], 0
    s_setprio 3
    v_cvt_pk_bf16_f32 v106, v94, v95
    v_cvt_pk_bf16_f32 v74, v86, v87
    v_cvt_pk_bf16_f32 v79, v92, v93
    s_setprio 0
    v_mfma_f32_16x16x32_bf16 v[94:97], v[74:77], v[66:69], 0
    s_setprio 3
    v_cvt_pk_bf16_f32 v78, v90, v91
    v_cvt_pk_bf16_f32 v109, v100, v101
    v_cvt_pk_bf16_f32 v108, v98, v99
    s_setprio 0
    v_mfma_f32_16x16x32_bf16 v[98:101], v[76:79], v[70:73], 0
    ds_write_b128 v3, v[106:109] offset:64
    s_setprio 3
    v_cvt_pk_bf16_f32 v102, v94, v95
    v_add_u32 v2, s55, v2
    v_cvt_pk_bf16_f32 v103, v96, v97
    s_nop 2
    v_cvt_pk_bf16_f32 v105, v100, v101
    v_cvt_pk_bf16_f32 v104, v98, v99
    ds_write_b128 v3, v[102:105] offset:128
    v_add_u32 v3, s55, v3
    s_sub_u32 s55, 0, s55
    s_add_u32 s39, s39, 1
    s_waitcnt lgkmcnt(0)
    s_barrier
    s_cmp_lt_u32 s39, s38
    s_cbranch_scc1 L_Tloop
    s_branch L_end
L_S1:
    s_add_u32 s58, s61, 0x12000
    s_mov_b32 s70, s58
    s_add_u32 s58, s39, 0
    s_mul_i32 s69, s58, s41
    s_add_u32 s69, s69, s40
    s_mul_hi_u32 s56, s69, 0x4bda130
    s_mul_i32 s57, s56, 54
    s_sub_u32 s57, s69, s57
    s_mul_i32 s56, s56, 0x7c080
    s_mul_i32 s57, s57, 0x540
    s_add_u32 s71, s56, s57
    s_add_u32 s71, s71, s54
    s_cmp_lt_u32 s58, s38
    s_cselect_b32 s71, s71, 0x68a6c00
    s_waitcnt vmcnt(0)
    s_barrier
    v_lshlrev_b32 v58, 4, v62
    v_add_u32 v58, s66, v58
    ds_write_b128 v58, v[152:155]
    ds_write_b128 v58, v[156:159] offset:1024
    ds_write_b128 v58, v[160:163] offset:2048
    ds_write_b128 v58, v[164:167] offset:3072
    ds_write_b128 v58, v[168:171] offset:4096
    ds_write_b128 v58, v[172:175] offset:5120
    ds_write_b128 v58, v[176:179] offset:6144
    ds_write_b128 v58, v[180:183] offset:7168
    ds_write_b128 v58, v[184:187] offset:8192
    s_waitcnt lgkmcnt(0)
    s_barrier
    ds_read_b128 v[200:203], v11
    ds_read_b128 v[204:207], v11 offset:1024
    ds_read_b128 v[208:211], v11 offset:2048
    ds_read_b128 v[212:215], v11 offset:3072
    ds_read_b128 v[216:219], v11 offset:4096
    s_add_u32 s58, s39, 1
    s_mul_i32 s69, s58, s41
    s_add_u32 s69, s69, s40
    ds_read_b128 v[220:223], v11 offset:5120
    s_mul_hi_u32 s56, s69, 0x4bda130
    s_mul_i32 s57, s56, 54
    s_sub_u32 s57, s69, s57
    s_mul_i32 s56, s56, 0x7c080
    s_mul_i32 s57, s57, 0x540
    s_add_u32 s59, s56, s57
    s_add_u32 s59, s59, s54
    s_cmp_lt_u32 s58, s38
    s_cselect_b32 s59, s59, 0x68a6c00
    s_add_u32 m0, s70, 0
    v_and_b32 v44, 63, v0
    buffer_load_dwordx4 v1, s[4:7], s59 offen lds
    s_add_u32 m0, s70, 0x400
    v_lshrrev_b32 v45, 4, v44
    v_and_b32 v46, 15, v44
    v_mov_b32 v92, 0x3f803f80
    v_min_u32 v49, 11, v46
    buffer_load_dwordx4 v2, s[4:7], s59 offen lds
    s_add_u32 m0, s70, 0x800
    v_mul_u32_u24 v49, 0xc0, v49
    v_mov_b32 v93, 0x3f803f80
    v_add_u32 v47, v13, v49
    v_mov_b32 v94, 0x3f803f80
    buffer_load_dwordx4 v3, s[4:7], s59 offen lds
    ds_read_b128 v[32:35], v47
    ds_read_b128 v[36:39], v47 offset:64
    ds_read_b128 v[40:43], v47 offset:128
    s_add_u32 m0, s70, 0xc00
    v_mov_b32 v95, 0x3f803f80
    s_lshl_b32 s57, s37, 4
    buffer_load_dwordx4 v4, s[4:7], s59 offen lds
    s_add_u32 m0, s70, 0x1000
    s_add_u32 s57, s57, 0x23c00
    buffer_load_dwordx4 v5, s[4:7], s59 offen lds
    s_add_u32 m0, s70, 0x1400
    v_mov_b32 v48, s57
    buffer_load_dwordx4 v6, s[4:7], s59 offen lds
    ds_write_b128 v48, v[92:95]
    ds_write_b128 v48, v[92:95] offset:64
    s_add_u32 m0, s70, 0x1800
    s_waitcnt lgkmcnt(4)
    v_mfma_f32_16x16x32_bf16 v[224:227], v[200:203], v[32:35], 0
    buffer_load_dwordx4 v7, s[4:7], s59 offen lds
    s_waitcnt lgkmcnt(3)
    v_mfma_f32_16x16x32_bf16 v[224:227], v[204:207], v[36:39], v[224:227]
    s_add_u32 m0, s70, 0x1c00
    ds_read_b128 v[200:203], v11 offset:6144
    buffer_load_dwordx4 v8, s[4:7], s59 offen lds
    s_waitcnt lgkmcnt(3)
    v_mfma_f32_16x16x32_bf16 v[224:227], v[208:211], v[40:43], v[224:227]
    s_add_u32 m0, s70, 0x2000
    ds_read_b128 v[204:207], v11 offset:7168
    buffer_load_dwordx4 v9, s[4:7], s59 offen lds
    v_mfma_f32_16x16x32_bf16 v[228:231], v[212:215], v[32:35], 0
    ds_read_b128 v[208:211], v11 offset:8192
    ds_read_b128 v[212:215], v11 offset:9216
    v_mfma_f32_16x16x32_bf16 v[228:231], v[216:219], v[36:39], v[228:231]
    v_cvt_pk_bf16_f32 v68, v224, v225
    v_cvt_pk_bf16_f32 v69, v226, v227
    v_mfma_f32_16x16x32_bf16 v[228:231], v[220:223], v[40:43], v[228:231]
    ds_write_b128 v48, v[92:95] offset:128
    ds_read_b128 v[216:219], v11 offset:10240
    s_nop 5
    v_cvt_pk_bf16_f32 v70, v228, v229
    v_cvt_pk_bf16_f32 v71, v230, v231
    s_waitcnt lgkmcnt(5)
    v_mfma_f32_16x16x32_bf16 v[232:235], v[200:203], v[32:35], 0
    ds_read_b128 v[220:223], v11 offset:11264
    ds_read_b128 v[200:203], v11 offset:12288
    s_waitcnt lgkmcnt(6)
    v_mfma_f32_16x16x32_bf16 v[232:235], v[204:207], v[36:39], v[232:235]
    ds_read_b128 v[204:207], v11 offset:13312
    s_waitcnt lgkmcnt(6)
    v_mfma_f32_16x16x32_bf16 v[232:235], v[208:211], v[40:43], v[232:235]
    ds_read_b128 v[208:211], v11 offset:14336
    s_waitcnt lgkmcnt(6)
    v_mfma_f32_16x16x32_bf16 v[236:239], v[212:215], v[32:35], 0
    ds_read_b128 v[212:215], v11 offset:15360
    s_nop 2
    v_cvt_pk_bf16_f32 v72, v232, v233
    v_cvt_pk_bf16_f32 v73, v234, v235
    s_waitcnt lgkmcnt(5)
    v_mfma_f32_16x16x32_bf16 v[236:239], v[216:219], v[36:39], v[236:239]
    ds_read_b128 v[216:219], v11 offset:16384
    s_waitcnt lgkmcnt(5)
    v_mfma_f32_16x16x32_bf16 v[236:239], v[220:223], v[40:43], v[236:239]
    ds_read_b128 v[220:223], v11 offset:17408
    s_waitcnt lgkmcnt(5)
    v_mfma_f32_16x16x32_bf16 v[224:227], v[200:203], v[32:35], 0
    ds_read_b128 v[200:203], v11 offset:18432
    s_waitcnt lgkmcnt(5)
    v_mfma_f32_16x16x32_bf16 v[224:227], v[204:207], v[36:39], v[224:227]
    ds_read_b128 v[204:207], v11 offset:19456
    v_cvt_pk_bf16_f32 v74, v236, v237
    s_waitcnt lgkmcnt(5)
    v_mfma_f32_16x16x32_bf16 v[224:227], v[208:211], v[40:43], v[224:227]
    ds_read_b128 v[208:211], v11 offset:20480
    v_cvt_pk_bf16_f32 v75, v238, v239
    s_waitcnt lgkmcnt(5)
    v_mfma_f32_16x16x32_bf16 v[228:231], v[212:215], v[32:35], 0
    ds_read_b128 v[212:215], v11 offset:21504
    s_nop 2
    v_cvt_pk_bf16_f32 v76, v224, v225
    v_cvt_pk_bf16_f32 v77, v226, v227
    s_waitcnt lgkmcnt(5)
    v_mfma_f32_16x16x32_bf16 v[228:231], v[216:219], v[36:39], v[228:231]
    ds_read_b128 v[216:219], v11 offset:22528
    s_waitcnt lgkmcnt(5)
    v_mfma_f32_16x16x32_bf16 v[228:231], v[220:223], v[40:43], v[228:231]
    ds_read_b128 v[220:223], v11 offset:23552
    s_waitcnt lgkmcnt(5)
    v_mfma_f32_16x16x32_bf16 v[232:235], v[200:203], v[32:35], 0
    ds_read_b128 v[200:203], v11 offset:24576
    s_waitcnt lgkmcnt(5)
    v_mfma_f32_16x16x32_bf16 v[232:235], v[204:207], v[36:39], v[232:235]
    ds_read_b128 v[204:207], v11 offset:25600
    v_cvt_pk_bf16_f32 v78, v228, v229
    s_waitcnt lgkmcnt(5)
    v_mfma_f32_16x16x32_bf16 v[232:235], v[208:211], v[40:43], v[232:235]
    ds_read_b128 v[208:211], v11 offset:26624
    v_cvt_pk_bf16_f32 v79, v230, v231
    s_waitcnt lgkmcnt(5)
    v_mfma_f32_16x16x32_bf16 v[236:239], v[212:215], v[32:35], 0
    ds_read_b128 v[212:215], v11 offset:27648
    s_nop 2
    v_cvt_pk_bf16_f32 v80, v232, v233
    v_cvt_pk_bf16_f32 v81, v234, v235
    v_mfma_f32_16x16x32_bf16 v[188:191], v[32:35], v[32:35], 0
    v_add_u32 v47, 0xffff7000, v47
    s_waitcnt lgkmcnt(5)
    v_mfma_f32_16x16x32_bf16 v[236:239], v[216:219], v[36:39], v[236:239]
    ds_read_b128 v[216:219], v11 offset:28672
    s_waitcnt lgkmcnt(5)
    v_mfma_f32_16x16x32_bf16 v[236:239], v[220:223], v[40:43], v[236:239]
    ds_read_b128 v[220:223], v11 offset:29696
    s_waitcnt lgkmcnt(5)
    v_mfma_f32_16x16x32_bf16 v[224:227], v[200:203], v[32:35], 0
    ds_read_b128 v[200:203], v11 offset:30720
    s_waitcnt lgkmcnt(5)
    v_mfma_f32_16x16x32_bf16 v[224:227], v[204:207], v[36:39], v[224:227]
    ds_read_b128 v[204:207], v11 offset:31744
    v_cvt_pk_bf16_f32 v82, v236, v237
    s_waitcnt lgkmcnt(5)
    v_mfma_f32_16x16x32_bf16 v[224:227], v[208:211], v[40:43], v[224:227]
    ds_read_b128 v[208:211], v11 offset:32768
    v_cvt_pk_bf16_f32 v83, v238, v239
    s_waitcnt lgkmcnt(5)
    v_mfma_f32_16x16x32_bf16 v[228:231], v[212:215], v[32:35], 0
    ds_read_b128 v[212:215], v11 offset:33792
    v_mfma_f32_16x16x32_bf16 v[188:191], v[36:39], v[36:39], v[188:191]
    v_cvt_pk_bf16_f32 v84, v224, v225
    v_cvt_pk_bf16_f32 v85, v226, v227
    v_mfma_f32_16x16x32_bf16 v[188:191], v[40:43], v[40:43], v[188:191]
    s_lshl_b32 s57, s37, 6
    s_waitcnt lgkmcnt(5)
    v_mfma_f32_16x16x32_bf16 v[228:231], v[216:219], v[36:39], v[228:231]
    s_add_u32 s57, s57, 0x23d00
    ds_read_b128 v[216:219], v11 offset:34816
    v_lshlrev_b32 v48, 2, v46
    s_waitcnt lgkmcnt(5)
    v_mfma_f32_16x16x32_bf16 v[228:231], v[220:223], v[40:43], v[228:231]
    ds_read_b128 v[220:223], v11 offset:35840
    v_cndmask_b32_e64 v188, v188, v189, s[46:47]
    s_waitcnt lgkmcnt(5)
    v_mfma_f32_16x16x32_bf16 v[232:235], v[200:203], v[32:35], 0
    v_cndmask_b32_e64 v188, v188, v190, s[48:49]
    v_add_u32 v48, s57, v48
    s_waitcnt lgkmcnt(4)
    v_mfma_f32_16x16x32_bf16 v[232:235], v[204:207], v[36:39], v[232:235]
    v_cvt_pk_bf16_f32 v86, v228, v229
    v_cvt_pk_bf16_f32 v87, v230, v231
    s_waitcnt lgkmcnt(3)
    v_mfma_f32_16x16x32_bf16 v[232:235], v[208:211], v[40:43], v[232:235]
    v_cndmask_b32_e64 v188, v188, v191, s[50:51]
    v_mov_b32 v131, 0
    s_waitcnt lgkmcnt(2)
    v_mfma_f32_16x16x32_bf16 v[236:239], v[212:215], v[32:35], 0
    v_mov_b32 v135, 0
    v_mov_b32 v139, 0
    v_mfma_f32_16x16x32_bf16 v[192:195], v[92:95], v[32:35], 0
    v_cvt_pk_bf16_f32 v88, v232, v233
    v_cvt_pk_bf16_f32 v89, v234, v235
    v_mfma_f32_16x16x32_bf16 v[192:195], v[92:95], v[36:39], v[192:195]
    s_mov_b32 s60, 0x68a6c00
    v_mov_b32 v143, 0
    v_mov_b32 v147, 0
    s_waitcnt lgkmcnt(1)
    v_mfma_f32_16x16x32_bf16 v[236:239], v[216:219], v[36:39], v[236:239]
    v_mov_b32 v151, 0
    v_mov_b32 v179, 0
    s_waitcnt lgkmcnt(0)
    v_mfma_f32_16x16x32_bf16 v[236:239], v[220:223], v[40:43], v[236:239]
    v_mfma_f32_16x16x32_bf16 v[192:195], v[92:95], v[40:43], v[192:195]
    v_mfma_f32_16x16x32_bf16 v[196:199], v[32:35], v[68:71], 0
    v_cvt_pk_bf16_f32 v90, v236, v237
    v_cvt_pk_bf16_f32 v91, v238, v239
    v_mfma_f32_16x16x32_bf16 v[196:199], v[36:39], v[72:75], v[196:199]
    s_mov_b64 exec, s[44:45]
    ds_write_b128 v47, v[68:71]
    ds_write_b128 v47, v[72:75] offset:64
    ds_write_b128 v47, v[76:79] offset:128
    ds_write_b128 v47, v[80:83] offset:9216
    ds_write_b128 v47, v[84:87] offset:9280
    ds_write_b128 v47, v[88:91] offset:9344
    s_mov_b64 exec, -1
    v_mfma_f32_16x16x32_bf16 v[196:199], v[40:43], v[76:79], v[196:199]
    v_mul_f32 v192, v192, v192
    v_fmamk_f32 v188, v192, 0xbc2aaaab, v188
    s_nop 4
    v_cndmask_b32_e64 v196, v196, v197, s[46:47]
    v_cndmask_b32_e64 v196, v196, v198, s[48:49]
    v_cndmask_b32_e64 v196, v196, v199, s[50:51]
    s_mov_b64 exec, s[42:43]
    ds_write_b32 v48, v188
    ds_write_b32 v48, v196 offset:256
    s_mov_b64 exec, -1
    s_waitcnt vmcnt(0) lgkmcnt(0)
    s_barrier
    s_setprio 1
    ds_read_b128 v[32:35], v10
    ds_read_b128 v[36:39], v10 offset:64
    ds_read_b128 v[40:43], v10 offset:128
    ds_read_b128 v[188:191], v12
    ds_read_b128 v[192:195], v12 offset:64
    s_mov_b32 s3, s59
    s_mov_b32 s60, s71
    s_add_u32 s58, s39, 2
    ds_read_b128 v[196:199], v12 offset:128
    s_mul_i32 s69, s58, s41
    s_add_u32 s69, s69, s40
    s_mul_hi_u32 s56, s69, 0x4bda130
    ds_read_b32 v30, v16 offset:256
    s_mul_i32 s57, s56, 54
    ds_read_b128 v[44:47], v10 offset:3072
    s_sub_u32 s57, s69, s57
    s_mul_i32 s56, s56, 0x7c080
    s_mul_i32 s57, s57, 0x540
    ds_read_b128 v[48:51], v10 offset:3136
    s_add_u32 s59, s56, s57
    s_mov_b32 s71, s3
    s_add_u32 s59, s59, s54
    ds_read_b128 v[52:55], v10 offset:3200
    s_cmp_lt_u32 s58, s38
    s_cselect_b32 s59, s59, 0x68a6c00
    s_add_u32 m0, s61, 0
    ds_read_b128 v[56:59], v10 offset:6144
    s_waitcnt lgkmcnt(10)
    v_mfma_f32_16x16x32_bf16 v[224:227], v[32:35], v[32:35], 0
    ds_read_b128 v[60:63], v10 offset:6208
    s_waitcnt lgkmcnt(9)
    buffer_load_dwordx4 v1, s[4:7], s59 offen lds
    v_mfma_f32_16x16x32_bf16 v[224:227], v[36:39], v[36:39], v[224:227]
    s_add_u32 m0, s61, 0x400
    ds_read_b128 v[64:67], v10 offset:6272
    buffer_load_dwordx4 v2, s[4:7], s59 offen lds
    v_mfma_f32_16x16x32_bf16 v[224:227], v[40:43], v[40:43], v[224:227]
    s_add_u32 m0, s61, 0x800
    ds_read_b128 v[200:203], v11
    buffer_load_dwordx4 v3, s[4:7], s59 offen lds
    s_waitcnt lgkmcnt(10)
    v_mfma_f32_16x16x32_bf16 v[228:231], v[188:191], v[32:35], 0
    s_add_u32 m0, s61, 0xc00
    ds_read_b128 v[204:207], v11 offset:1024
    ds_read_b128 v[208:211], v11 offset:2048
    s_waitcnt lgkmcnt(11)
    v_mfma_f32_16x16x32_bf16 v[228:231], v[192:195], v[36:39], v[228:231]
    s_mov_b64 exec, s[42:43]
    ds_write_b128 v15, v[224:227]
    s_mov_b64 exec, -1
    s_waitcnt lgkmcnt(11)
    v_mfma_f32_16x16x32_bf16 v[228:231], v[196:199], v[40:43], v[228:231]
    s_waitcnt lgkmcnt(7)
    buffer_load_dwordx4 v4, s[4:7], s59 offen lds
    v_mfma_f32_16x16x32_bf16 v[232:235], v[44:47], v[44:47], 0
    s_add_u32 m0, s61, 0x1000
    v_mfma_f32_16x16x32_bf16 v[232:235], v[48:51], v[48:51], v[232:235]
    v_mov_b32_dpp v30, v228 quad_perm:[0,1,2,3] row_mask:0x1 bank_mask:0xf
    v_mov_b32_dpp v27, v229 quad_perm:[0,1,2,3] row_mask:0x1 bank_mask:0xf
    v_mfma_f32_16x16x32_bf16 v[232:235], v[52:55], v[52:55], v[232:235]
    buffer_load_dwordx4 v5, s[4:7], s59 offen lds
    v_mfma_f32_16x16x32_bf16 v[236:239], v[188:191], v[44:47], 0
    s_add_u32 m0, s61, 0x1400
    ds_read_b128 v[212:215], v11 offset:3072
    ds_read_b128 v[216:219], v11 offset:4096
    v_mfma_f32_16x16x32_bf16 v[236:239], v[192:195], v[48:51], v[236:239]
    ds_read_b128 v[220:223], v11 offset:5120
    s_mov_b64 exec, s[42:43]
    ds_write_b128 v15, v[232:235] offset:256
    s_mov_b64 exec, -1
    v_mfma_f32_16x16x32_bf16 v[236:239], v[196:199], v[52:55], v[236:239]
    s_waitcnt lgkmcnt(10)
    v_mfma_f32_16x16x32_bf16 v[224:227], v[56:59], v[56:59], 0
    s_waitcnt lgkmcnt(9)
    v_mfma_f32_16x16x32_bf16 v[224:227], v[60:63], v[60:63], v[224:227]
    v_mov_b32_dpp v30, v236 quad_perm:[0,1,2,3] row_mask:0x2 bank_mask:0xf
    v_mov_b32_dpp v27, v237 quad_perm:[0,1,2,3] row_mask:0x2 bank_mask:0xf
    s_waitcnt lgkmcnt(8)
    v_mfma_f32_16x16x32_bf16 v[224:227], v[64:67], v[64:67], v[224:227]
    buffer_load_dwordx4 v6, s[4:7], s59 offen lds
    v_mfma_f32_16x16x32_bf16 v[228:231], v[188:191], v[56:59], 0
    s_add_u32 m0, s61, 0x1800
    v_mfma_f32_16x16x32_bf16 v[228:231], v[192:195], v[60:63], v[228:231]
    s_mov_b64 exec, s[42:43]
    ds_write_b128 v15, v[224:227] offset:512
    s_mov_b64 exec, -1
    v_mfma_f32_16x16x32_bf16 v[228:231], v[196:199], v[64:67], v[228:231]
    ds_read_b32 v248, v16
    s_waitcnt lgkmcnt(9)
    v_mfma_f32_16x16x32_bf16 v[232:235], v[200:203], v[32:35], 0
    s_waitcnt lgkmcnt(8)
    v_mfma_f32_16x16x32_bf16 v[232:235], v[204:207], v[36:39], v[232:235]
    v_mov_b32_dpp v30, v228 quad_perm:[0,1,2,3] row_mask:0x4 bank_mask:0xf
    v_mov_b32_dpp v27, v229 quad_perm:[0,1,2,3] row_mask:0x4 bank_mask:0xf
    s_waitcnt lgkmcnt(7)
    v_mfma_f32_16x16x32_bf16 v[232:235], v[208:211], v[40:43], v[232:235]
    v_mul_f32 v253, v27, v27
    v_mfma_f32_16x16x32_bf16 v[236:239], v[200:203], v[44:47], 0
    v_mfma_f32_16x16x32_bf16 v[236:239], v[204:207], v[48:51], v[236:239]
    v_cvt_pk_bf16_f32 v68, v232, v233
    v_cvt_pk_bf16_f32 v69, v234, v235
    v_mfma_f32_16x16x32_bf16 v[236:239], v[208:211], v[52:55], v[236:239]
    v_mfma_f32_16x16x32_bf16 v[224:227], v[200:203], v[56:59], 0
    v_mfma_f32_16x16x32_bf16 v[224:227], v[204:207], v[60:63], v[224:227]
    s_waitcnt lgkmcnt(0)
    v_fmamk_f32 v248, v253, 0xbc2aaaab, v248
    v_cvt_pk_bf16_f32 v80, v236, v237
    v_mfma_f32_16x16x32_bf16 v[224:227], v[208:211], v[64:67], v[224:227]
    v_max_f32 v248, 0, v248
    v_cvt_pk_bf16_f32 v81, v238, v239
    v_mfma_f32_16x16x32_bf16 v[228:231], v[212:215], v[32:35], 0
    ds_read_b128 v[200:203], v11 offset:6144
    v_add_f32 v248, 0x3a7ba882, v248
    v_mfma_f32_16x16x32_bf16 v[228:231], v[216:219], v[36:39], v[228:231]
    ds_read_b128 v[204:207], v11 offset:7168
    v_cvt_pk_bf16_f32 v92, v224, v225
    v_mfma_f32_16x16x32_bf16 v[228:231], v[220:223], v[40:43], v[228:231]
    v_rsq_f32 v249, v248
    v_mfma_f32_16x16x32_bf16 v[232:235], v[212:215], v[44:47], 0
    ds_write_b32 v17, v249
    v_mfma_f32_16x16x32_bf16 v[232:235], v[216:219], v[48:51], v[232:235]
    ds_read_b128 v[208:211], v11 offset:8192
    v_mul_f32 v248, v248, v249
    v_mfma_f32_16x16x32_bf16 v[232:235], v[220:223], v[52:55], v[232:235]
    v_cvt_pk_bf16_f32 v248, v248, v248
    v_cvt_pk_bf16_f32 v93, v226, v227
    v_mfma_f32_16x16x32_bf16 v[236:239], v[212:215], v[56:59], 0
    ds_write_b16 v18, v248
    v_mfma_f32_16x16x32_bf16 v[236:239], v[216:219], v[60:63], v[236:239]
    ds_read_b32 v243, v19 offset:192
    buffer_load_dwordx4 v7, s[4:7], s59 offen lds
    v_mfma_f32_16x16x32_bf16 v[236:239], v[220:223], v[64:67], v[236:239]
    s_add_u32 m0, s61, 0x1c00
    v_cvt_pk_bf16_f32 v70, v228, v229
    v_cvt_pk_bf16_f32 v71, v230, v231
    s_waitcnt lgkmcnt(5)
    v_mfma_f32_16x16x32_bf16 v[224:227], v[200:203], v[32:35], 0
    ds_read_b128 v[212:215], v11 offset:9216
    ds_read_b128 v[216:219], v11 offset:10240
    s_waitcnt lgkmcnt(6)
    v_mfma_f32_16x16x32_bf16 v[224:227], v[204:207], v[36:39], v[224:227]
    ds_read_b128 v[220:223], v11 offset:11264
    v_cvt_pk_bf16_f32 v82, v232, v233
    v_mfma_f32_16x16x32_bf16 v[228:231], v[200:203], v[44:47], 0
    v_cvt_pk_bf16_f32 v83, v234, v235
    v_cvt_pk_bf16_f32 v94, v236, v237
    s_waitcnt lgkmcnt(5)
    v_mfma_f32_16x16x32_bf16 v[224:227], v[208:211], v[40:43], v[224:227]
    v_cvt_pk_bf16_f32 v95, v238, v239
    v_mul_f32 v30, v30, v249
    v_mfma_f32_16x16x32_bf16 v[228:231], v[204:207], v[48:51], v[228:231]
    v_mov_b32 v254, 0xff800000
    v_mfma_f32_16x16x32_bf16 v[228:231], v[208:211], v[52:55], v[228:231]
    v_cvt_pk_bf16_f32 v72, v224, v225
    s_waitcnt lgkmcnt(3)
    v_mul_f32 v244, 0x3e800000, v243
    v_mfma_f32_16x16x32_bf16 v[232:235], v[200:203], v[56:59], 0
    v_mul_f32 v30, v30, v243
    v_cvt_pk_bf16_f32 v73, v226, v227
    v_mfma_f32_16x16x32_bf16 v[232:235], v[204:207], v[60:63], v[232:235]
    v_cndmask_b32_e64 v30, v254, v30, s[52:53]
    v_cvt_pk_bf16_f32 v84, v228, v229
    v_mfma_f32_16x16x32_bf16 v[232:235], v[208:211], v[64:67], v[232:235]
    ds_read_b128 v[200:203], v11 offset:12288
    v_mov_b32 v253, v30
    s_waitcnt lgkmcnt(3)
    v_mfma_f32_16x16x32_bf16 v[236:239], v[212:215], v[32:35], 0
    ds_read_b128 v[204:207], v11 offset:13312
    v_max_f32_dpp v253, v253, v253 row_ror:8 row_mask:0xf bank_mask:0xf
    s_waitcnt lgkmcnt(3)
    v_mfma_f32_16x16x32_bf16 v[236:239], v[216:219], v[36:39], v[236:239]
    ds_read_b128 v[208:211], v11 offset:14336
    v_max_f32_dpp v253, v253, v253 row_ror:4 row_mask:0xf bank_mask:0xf
    s_waitcnt lgkmcnt(3)
    v_mfma_f32_16x16x32_bf16 v[236:239], v[220:223], v[40:43], v[236:239]
    v_cvt_pk_bf16_f32 v85, v230, v231
    v_max_f32_dpp v253, v253, v253 row_ror:2 row_mask:0xf bank_mask:0xf
    v_mfma_f32_16x16x32_bf16 v[224:227], v[212:215], v[44:47], 0
    v_max_f32_dpp v253, v253, v253 row_ror:1 row_mask:0xf bank_mask:0xf
    v_cvt_pk_bf16_f32 v96, v232, v233
    v_mfma_f32_16x16x32_bf16 v[224:227], v[216:219], v[48:51], v[224:227]
    v_mov_b32 v254, v253
    v_cvt_pk_bf16_f32 v97, v234, v235
    v_mfma_f32_16x16x32_bf16 v[224:227], v[220:223], v[52:55], v[224:227]
    buffer_load_dwordx4 v8, s[4:7], s59 offen lds
    v_mfma_f32_16x16x32_bf16 v[228:231], v[212:215], v[56:59], 0
    s_add_u32 m0, s61, 0x2000
    v_permlane32_swap_b32 v253, v254
    v_mfma_f32_16x16x32_bf16 v[228:231], v[216:219], v[60:63], v[228:231]
    v_max_f32 v253, v253, v254
    v_cvt_pk_bf16_f32 v74, v236, v237
    v_mfma_f32_16x16x32_bf16 v[228:231], v[220:223], v[64:67], v[228:231]
    v_mov_b32 v254, v253
    v_cvt_pk_bf16_f32 v75, v238, v239
    s_waitcnt lgkmcnt(2)
    v_mfma_f32_16x16x32_bf16 v[232:235], v[200:203], v[32:35], 0
    v_permlane16_swap_b32 v253, v254
    s_waitcnt lgkmcnt(1)
    v_mfma_f32_16x16x32_bf16 v[232:235], v[204:207], v[36:39], v[232:235]
    ds_read_b128 v[212:215], v11 offset:15360
    ds_read_b128 v[216:219], v11 offset:16384
    s_waitcnt lgkmcnt(2)
    v_mfma_f32_16x16x32_bf16 v[232:235], v[208:211], v[40:43], v[232:235]
    ds_read_b128 v[220:223], v11 offset:17408
    v_max_f32 v253, v253, v254
    v_mfma_f32_16x16x32_bf16 v[236:239], v[200:203], v[44:47], 0
    v_sub_f32 v30, v30, v253
    v_cvt_pk_bf16_f32 v86, v224, v225
    v_mfma_f32_16x16x32_bf16 v[236:239], v[204:207], v[48:51], v[236:239]
    v_cvt_pk_bf16_f32 v87, v226, v227
    v_cvt_pk_bf16_f32 v98, v228, v229
    v_mfma_f32_16x16x32_bf16 v[236:239], v[208:211], v[52:55], v[236:239]
    v_exp_f32 v30, v30
    v_mfma_f32_16x16x32_bf16 v[224:227], v[200:203], v[56:59], 0
    v_mul_f32 v30, v30, v24
    v_cvt_pk_bf16_f32 v99, v230, v231
    v_mfma_f32_16x16x32_bf16 v[224:227], v[204:207], v[60:63], v[224:227]
    v_mov_b32 v253, v30
    v_cvt_pk_bf16_f32 v76, v232, v233
    v_mfma_f32_16x16x32_bf16 v[224:227], v[208:211], v[64:67], v[224:227]
    v_add_f32_dpp v253, v253, v253 row_ror:8 row_mask:0xf bank_mask:0xf
    v_cvt_pk_bf16_f32 v77, v234, v235
    s_waitcnt lgkmcnt(2)
    v_mfma_f32_16x16x32_bf16 v[228:231], v[212:215], v[32:35], 0
    v_add_f32_dpp v253, v253, v253 row_ror:4 row_mask:0xf bank_mask:0xf
    v_cvt_pk_bf16_f32 v88, v236, v237
    s_waitcnt lgkmcnt(1)
    v_mfma_f32_16x16x32_bf16 v[228:231], v[216:219], v[36:39], v[228:231]
    v_add_f32_dpp v253, v253, v253 row_ror:2 row_mask:0xf bank_mask:0xf
    v_cvt_pk_bf16_f32 v89, v238, v239
    s_waitcnt lgkmcnt(0)
    v_mfma_f32_16x16x32_bf16 v[228:231], v[220:223], v[40:43], v[228:231]
    v_add_f32_dpp v253, v253, v253 row_ror:1 row_mask:0xf bank_mask:0xf
    v_cvt_pk_bf16_f32 v100, v224, v225
    v_mfma_f32_16x16x32_bf16 v[232:235], v[212:215], v[44:47], 0
    v_mov_b32 v254, v253
    v_cvt_pk_bf16_f32 v101, v226, v227
    v_mfma_f32_16x16x32_bf16 v[232:235], v[216:219], v[48:51], v[232:235]
    v_permlane32_swap_b32 v253, v254
    v_mfma_f32_16x16x32_bf16 v[232:235], v[220:223], v[52:55], v[232:235]
    ds_read_b128 v[116:119], v13
    ds_read_b128 v[120:123], v13 offset:64
    v_mfma_f32_16x16x32_bf16 v[236:239], v[212:215], v[56:59], 0
    ds_read_b128 v[124:127], v13 offset:128
    v_add_f32 v253, v253, v254
    v_mfma_f32_16x16x32_bf16 v[236:239], v[216:219], v[60:63], v[236:239]
    ds_read_b128 v[152:155], v19
    v_mov_b32 v254, v253
    v_mfma_f32_16x16x32_bf16 v[236:239], v[220:223], v[64:67], v[236:239]
    buffer_load_dwordx4 v9, s[4:7], s59 offen lds
    v_mfma_f32_16x16x32_bf16 v[188:191], v[32:35], v[68:71], 0
    v_permlane16_swap_b32 v253, v254
    v_mfma_f32_16x16x32_bf16 v[188:191], v[36:39], v[72:75], v[188:191]
    ds_read_b128 v[156:159], v19 offset:64
    v_add_f32 v253, v253, v254
    v_mfma_f32_16x16x32_bf16 v[192:195], v[44:47], v[68:71], 0
    v_rcp_f32 v253, v253
    v_mfma_f32_16x16x32_bf16 v[192:195], v[48:51], v[72:75], v[192:195]
    ds_read_b128 v[160:163], v19 offset:128
    v_cvt_pk_bf16_f32 v78, v228, v229
    v_mfma_f32_16x16x32_bf16 v[196:199], v[56:59], v[68:71], 0
    v_cvt_pk_bf16_f32 v79, v230, v231
    v_mul_f32 v30, v30, v249
    v_mfma_f32_16x16x32_bf16 v[196:199], v[60:63], v[72:75], v[196:199]
    ds_read_b32 v240, v20
    ds_read_b32 v241, v20 offset:64
    v_mfma_f32_16x16x32_bf16 v[188:191], v[40:43], v[76:79], v[188:191]
    ds_read_b32 v242, v20 offset:128
    ds_read_b128 v[164:167], v19 offset:256
    v_mfma_f32_16x16x32_bf16 v[192:195], v[52:55], v[76:79], v[192:195]
    ds_read_b128 v[168:171], v19 offset:320
    v_mul_f32 v30, v30, v253
    v_mfma_f32_16x16x32_bf16 v[196:199], v[64:67], v[76:79], v[196:199]
    v_cvt_pk_bf16_f32 v30, v30, v30
    v_cvt_pk_bf16_f32 v90, v232, v233
    s_waitcnt lgkmcnt(10)
    v_mfma_f32_16x16x32_bf16 v[224:227], v[116:119], v[68:71], 0
    ds_write_b16 v18, v30 offset:128
    s_waitcnt lgkmcnt(10)
    v_mfma_f32_16x16x32_bf16 v[224:227], v[120:123], v[72:75], v[224:227]
    v_cvt_pk_bf16_f32 v91, v234, v235
    v_cvt_pk_bf16_f32 v102, v236, v237
    s_waitcnt lgkmcnt(9)
    v_mfma_f32_16x16x32_bf16 v[224:227], v[124:127], v[76:79], v[224:227]
    v_cvt_pk_bf16_f32 v103, v238, v239
    s_waitcnt lgkmcnt(8)
    v_mul_f32 v188, v188, v152
    v_mfma_f32_16x16x32_bf16 v[68:71], v[32:35], v[80:83], 0
    v_mul_f32 v189, v189, v153
    v_mul_f32 v190, v190, v154
    v_mfma_f32_16x16x32_bf16 v[68:71], v[36:39], v[84:87], v[68:71]
    v_mul_f32 v245, v224, v243
    v_mul_f32 v191, v191, v155
    v_mfma_f32_16x16x32_bf16 v[68:71], v[40:43], v[88:91], v[68:71]
    s_waitcnt lgkmcnt(7)
    v_mul_f32 v192, v192, v156
    v_mul_f32 v193, v193, v157
    v_mfma_f32_16x16x32_bf16 v[72:75], v[44:47], v[80:83], 0
    v_mul_f32 v194, v194, v158
    v_mul_f32 v195, v195, v159
    v_mfma_f32_16x16x32_bf16 v[72:75], v[48:51], v[84:87], v[72:75]
    s_waitcnt lgkmcnt(6)
    v_mul_f32 v196, v196, v160
    v_mul_f32 v197, v197, v161
    v_mfma_f32_16x16x32_bf16 v[72:75], v[52:55], v[88:91], v[72:75]
    v_mul_f32 v198, v198, v162
    v_mul_f32 v199, v199, v163
    v_mfma_f32_16x16x32_bf16 v[76:79], v[56:59], v[80:83], 0
    v_max3_f32 v250, v188, v189, v245
    v_max3_f32 v251, v190, v191, v192
    v_mfma_f32_16x16x32_bf16 v[76:79], v[60:63], v[84:87], v[76:79]
    ds_read_b128 v[200:203], v11 offset:18432
    v_max3_f32 v250, v250, v193, v194
    v_mfma_f32_16x16x32_bf16 v[76:79], v[64:67], v[88:91], v[76:79]
    ds_read_b128 v[204:207], v11 offset:19456
    v_max3_f32 v251, v251, v195, v196
    v_mfma_f32_16x16x32_bf16 v[228:231], v[116:119], v[80:83], 0
    v_max3_f32 v250, v250, v197, v198
    v_mfma_f32_16x16x32_bf16 v[80:83], v[32:35], v[92:95], 0
    ds_read_b128 v[208:211], v11 offset:20480
    v_max3_f32 v250, v250, v251, v199
    v_mfma_f32_16x16x32_bf16 v[80:83], v[36:39], v[96:99], v[80:83]
    v_mov_b32 v251, v250
    v_mfma_f32_16x16x32_bf16 v[80:83], v[40:43], v[100:103], v[80:83]
    v_permlane32_swap_b32 v250, v251
    v_mfma_f32_16x16x32_bf16 v[228:231], v[120:123], v[84:87], v[228:231]
    v_max_f32 v250, v250, v251
    v_mfma_f32_16x16x32_bf16 v[84:87], v[44:47], v[92:95], 0
    v_mov_b32 v251, v250
    v_mfma_f32_16x16x32_bf16 v[84:87], v[48:51], v[96:99], v[84:87]
    v_permlane16_swap_b32 v250, v251
    v_mfma_f32_16x16x32_bf16 v[84:87], v[52:55], v[100:103], v[84:87]
    v_max_f32 v250, v250, v251
    v_mfma_f32_16x16x32_bf16 v[228:231], v[124:127], v[88:91], v[228:231]
    s_waitcnt lgkmcnt(8)
    v_mul_f32_e64 v250, -v250, v240
    v_mfma_f32_16x16x32_bf16 v[88:91], v[56:59], v[92:95], 0
    v_fma_f32 v188, v188, v240, v250
    v_fma_f32 v189, v189, v240, v250
    v_mfma_f32_16x16x32_bf16 v[88:91], v[60:63], v[96:99], v[88:91]
    v_fma_f32 v190, v190, v240, v250
    v_fma_f32 v191, v191, v240, v250
    v_mfma_f32_16x16x32_bf16 v[88:91], v[64:67], v[100:103], v[88:91]
    ds_read_b128 v[212:215], v11 offset:21504
    v_fma_f32 v192, v192, v240, v250
    v_mfma_f32_16x16x32_bf16 v[232:235], v[116:119], v[92:95], 0
    ds_read_b128 v[216:219], v11 offset:22528
    v_fma_f32 v193, v193, v240, v250
    v_mfma_f32_16x16x32_bf16 v[232:235], v[120:123], v[96:99], v[232:235]
    v_fma_f32 v194, v194, v240, v250
    v_mul_f32 v246, v228, v243
    v_mfma_f32_16x16x32_bf16 v[232:235], v[124:127], v[100:103], v[232:235]
    ds_read_b128 v[220:223], v11 offset:23552
    v_fma_f32 v195, v195, v240, v250
    s_waitcnt lgkmcnt(5)
    v_mfma_f32_16x16x32_bf16 v[236:239], v[32:35], v[200:203], 0
    v_fma_f32 v196, v196, v240, v250
    v_fma_f32 v197, v197, v240, v250
    s_waitcnt lgkmcnt(4)
    v_mfma_f32_16x16x32_bf16 v[236:239], v[36:39], v[204:207], v[236:239]
    v_fma_f32 v198, v198, v240, v250
    v_fma_f32 v199, v199, v240, v250
    s_waitcnt lgkmcnt(3)
    v_mfma_f32_16x16x32_bf16 v[236:239], v[40:43], v[208:211], v[236:239]
    v_mul_f32 v247, v232, v243
    v_fma_f32 v245, v245, v240, v250
    v_mfma_f32_16x16x32_bf16 v[224:227], v[44:47], v[200:203], 0
    v_exp_f32 v188, v188
    v_mfma_f32_16x16x32_bf16 v[224:227], v[48:51], v[204:207], v[224:227]
    v_exp_f32 v189, v189
    v_mfma_f32_16x16x32_bf16 v[224:227], v[52:55], v[208:211], v[224:227]
    v_exp_f32 v190, v190
    v_mfma_f32_16x16x32_bf16 v[228:231], v[56:59], v[200:203], 0
    v_cvt_pk_bf16_f32 v104, v236, v237
    v_cvt_pk_bf16_f32 v105, v238, v239
    v_mfma_f32_16x16x32_bf16 v[228:231], v[60:63], v[204:207], v[228:231]
    v_exp_f32 v191, v191
    v_mfma_f32_16x16x32_bf16 v[228:231], v[64:67], v[208:211], v[228:231]
    v_exp_f32 v192, v192
    s_waitcnt lgkmcnt(2)
    v_mfma_f32_16x16x32_bf16 v[232:235], v[32:35], v[212:215], 0
    ds_read_b128 v[200:203], v11 offset:24576
    ds_read_b128 v[204:207], v11 offset:25600
    s_waitcnt lgkmcnt(3)
    v_mfma_f32_16x16x32_bf16 v[232:235], v[36:39], v[216:219], v[232:235]
    v_exp_f32 v193, v193
    s_waitcnt lgkmcnt(2)
    v_mfma_f32_16x16x32_bf16 v[232:235], v[40:43], v[220:223], v[232:235]
    v_cvt_pk_bf16_f32 v106, v224, v225
    v_cvt_pk_bf16_f32 v107, v226, v227
    v_mfma_f32_16x16x32_bf16 v[236:239], v[44:47], v[212:215], 0
    ds_read_b128 v[208:211], v11 offset:26624
    v_cvt_pk_bf16_f32 v128, v228, v229
    v_mfma_f32_16x16x32_bf16 v[236:239], v[48:51], v[216:219], v[236:239]
    v_exp_f32 v194, v194
    v_mfma_f32_16x16x32_bf16 v[236:239], v[52:55], v[220:223], v[236:239]
    v_exp_f32 v195, v195
    v_mfma_f32_16x16x32_bf16 v[224:227], v[56:59], v[212:215], 0
    v_exp_f32 v196, v196
    v_mfma_f32_16x16x32_bf16 v[224:227], v[60:63], v[216:219], v[224:227]
    v_cvt_pk_bf16_f32 v129, v230, v231
    v_cvt_pk_bf16_f32 v108, v232, v233
    v_mfma_f32_16x16x32_bf16 v[224:227], v[64:67], v[220:223], v[224:227]
    v_exp_f32 v197, v197
    s_waitcnt lgkmcnt(2)
    v_mfma_f32_16x16x32_bf16 v[228:231], v[32:35], v[200:203], 0
    v_exp_f32 v198, v198
    s_waitcnt lgkmcnt(1)
    v_mfma_f32_16x16x32_bf16 v[228:231], v[36:39], v[204:207], v[228:231]
    v_exp_f32 v199, v199
    s_waitcnt lgkmcnt(0)
    v_mfma_f32_16x16x32_bf16 v[228:231], v[40:43], v[208:211], v[228:231]
    v_cvt_pk_bf16_f32 v109, v234, v235
    v_mul_f32 v188, v188, v152
    v_mfma_f32_16x16x32_bf16 v[232:235], v[44:47], v[200:203], 0
    v_exp_f32 v245, v245
    v_mfma_f32_16x16x32_bf16 v[232:235], v[48:51], v[204:207], v[232:235]
    ds_read_b128 v[212:215], v11 offset:27648
    v_mul_f32 v189, v189, v153
    v_mfma_f32_16x16x32_bf16 v[232:235], v[52:55], v[208:211], v[232:235]
    v_mul_f32 v190, v190, v154
    v_cvt_pk_bf16_f32 v110, v236, v237
    v_mul_f32 v191, v191, v155
    v_cvt_pk_bf16_f32 v111, v238, v239
    v_mfma_f32_16x16x32_bf16 v[236:239], v[56:59], v[200:203], 0
    ds_read_b128 v[216:219], v11 offset:28672
    ds_read_b128 v[220:223], v11 offset:29696
    v_mfma_f32_16x16x32_bf16 v[236:239], v[60:63], v[204:207], v[236:239]
    v_mul_f32 v192, v192, v156
    v_mul_f32 v193, v193, v157
    v_mfma_f32_16x16x32_bf16 v[236:239], v[64:67], v[208:211], v[236:239]
    v_mul_f32 v194, v194, v158
    v_mul_f32 v195, v195, v159
    v_mul_f32 v196, v196, v160
    v_cvt_pk_bf16_f32 v132, v224, v225
    v_cvt_pk_bf16_f32 v133, v226, v227
    v_mul_f32 v197, v197, v161
    v_mul_f32 v198, v198, v162
    v_mul_f32 v199, v199, v163
    v_mul_f32 v245, v245, v244
    v_cvt_pk_bf16_f32 v172, v188, v189
    v_cvt_pk_bf16_f32 v173, v190, v191
    v_cvt_pk_bf16_f32 v174, v192, v193
    s_waitcnt lgkmcnt(2)
    v_mfma_f32_16x16x32_bf16 v[224:227], v[32:35], v[212:215], 0
    v_cvt_pk_bf16_f32 v112, v228, v229
    v_cvt_pk_bf16_f32 v113, v230, v231
    v_mfma_f32_16x16x32_bf16 v[228:231], v[44:47], v[212:215], 0
    v_cvt_pk_bf16_f32 v175, v194, v195
    v_cvt_pk_bf16_f32 v176, v196, v197
    v_cvt_pk_bf16_f32 v177, v198, v199
    v_cvt_pk_bf16_f32 v178, v245, 0
    s_waitcnt lgkmcnt(1)
    v_mfma_f32_16x16x32_bf16 v[224:227], v[36:39], v[216:219], v[224:227]
    ds_read_b128 v[200:203], v11 offset:30720
    v_mul_f32 v68, v68, v152
    s_waitcnt lgkmcnt(1)
    v_mfma_f32_16x16x32_bf16 v[224:227], v[40:43], v[220:223], v[224:227]
    ds_read_b128 v[204:207], v11 offset:31744
    v_mul_f32 v69, v69, v153
    v_mfma_f32_16x16x32_bf16 v[228:231], v[48:51], v[216:219], v[228:231]
    v_cvt_pk_bf16_f32 v114, v232, v233
    v_cvt_pk_bf16_f32 v115, v234, v235
    v_mfma_f32_16x16x32_bf16 v[228:231], v[52:55], v[220:223], v[228:231]
    ds_read_b128 v[208:211], v11 offset:32768
    v_mul_f32 v70, v70, v154
    v_mfma_f32_16x16x32_bf16 v[232:235], v[56:59], v[212:215], 0
    v_mul_f32 v71, v71, v155
    v_mul_f32 v72, v72, v156
    v_mfma_f32_16x16x32_bf16 v[232:235], v[60:63], v[216:219], v[232:235]
    v_mul_f32 v73, v73, v157
    v_mul_f32 v74, v74, v158
    v_mfma_f32_16x16x32_bf16 v[232:235], v[64:67], v[220:223], v[232:235]
    v_cvt_pk_bf16_f32 v136, v236, v237
    v_cvt_pk_bf16_f32 v137, v238, v239
    v_mul_f32 v75, v75, v159
    v_mul_f32 v76, v76, v160
    v_mul_f32 v77, v77, v161
    v_mul_f32 v78, v78, v162
    s_waitcnt lgkmcnt(2)
    v_mfma_f32_16x16x32_bf16 v[236:239], v[32:35], v[200:203], 0
    v_mul_f32 v79, v79, v163
    v_max3_f32 v253, v68, v69, v246
    s_waitcnt lgkmcnt(1)
    v_mfma_f32_16x16x32_bf16 v[236:239], v[36:39], v[204:207], v[236:239]
    v_max3_f32 v254, v70, v71, v72
    v_cvt_pk_bf16_f32 v116, v224, v225
    v_max3_f32 v253, v253, v73, v74
    v_cvt_pk_bf16_f32 v117, v226, v227
    v_mfma_f32_16x16x32_bf16 v[224:227], v[44:47], v[200:203], 0
    v_max3_f32 v254, v254, v75, v76
    v_max3_f32 v253, v253, v77, v78
    s_waitcnt lgkmcnt(0)
    v_mfma_f32_16x16x32_bf16 v[236:239], v[40:43], v[208:211], v[236:239]
    ds_read_b128 v[212:215], v11 offset:33792
    v_max3_f32 v253, v253, v254, v79
    v_mfma_f32_16x16x32_bf16 v[224:227], v[48:51], v[204:207], v[224:227]
    v_mov_b32 v254, v253
    v_cvt_pk_bf16_f32 v118, v228, v229
    v_mfma_f32_16x16x32_bf16 v[224:227], v[52:55], v[208:211], v[224:227]
    ds_read_b128 v[216:219], v11 offset:34816
    v_permlane32_swap_b32 v253, v254
    v_cvt_pk_bf16_f32 v119, v230, v231
    v_mfma_f32_16x16x32_bf16 v[228:231], v[56:59], v[200:203], 0
    ds_read_b128 v[220:223], v11 offset:35840
    v_max_f32 v253, v253, v254
    v_mfma_f32_16x16x32_bf16 v[228:231], v[60:63], v[204:207], v[228:231]
    v_mov_b32 v254, v253
    v_cvt_pk_bf16_f32 v140, v232, v233
    v_mfma_f32_16x16x32_bf16 v[228:231], v[64:67], v[208:211], v[228:231]
    v_permlane16_swap_b32 v253, v254
    v_cvt_pk_bf16_f32 v141, v234, v235
    v_max_f32 v253, v253, v254
    v_cvt_pk_bf16_f32 v120, v236, v237
    v_mul_f32_e64 v253, -v253, v241
    v_cvt_pk_bf16_f32 v121, v238, v239
    v_fma_f32 v68, v68, v241, v253
    s_waitcnt lgkmcnt(2)
    v_mfma_f32_16x16x32_bf16 v[232:235], v[32:35], v[212:215], 0
    v_fma_f32 v69, v69, v241, v253
    v_fma_f32 v70, v70, v241, v253
    v_mfma_f32_16x16x32_bf16 v[236:239], v[44:47], v[212:215], 0
    v_fma_f32 v71, v71, v241, v253
    v_fma_f32 v72, v72, v241, v253
    s_waitcnt lgkmcnt(1)
    v_mfma_f32_16x16x32_bf16 v[232:235], v[36:39], v[216:219], v[232:235]
    v_fma_f32 v73, v73, v241, v253
    v_fma_f32 v74, v74, v241, v253
    v_mfma_f32_16x16x32_bf16 v[236:239], v[48:51], v[216:219], v[236:239]
    v_fma_f32 v75, v75, v241, v253
    v_fma_f32 v76, v76, v241, v253
    s_waitcnt lgkmcnt(0)
    v_mfma_f32_16x16x32_bf16 v[232:235], v[40:43], v[220:223], v[232:235]
    v_fma_f32 v77, v77, v241, v253
    v_fma_f32 v78, v78, v241, v253
    v_mfma_f32_16x16x32_bf16 v[236:239], v[52:55], v[220:223], v[236:239]
    ds_read_b128 v[180:183], v19 offset:384
    v_cvt_pk_bf16_f32 v122, v224, v225
    v_cvt_pk_bf16_f32 v123, v226, v227
    v_mfma_f32_16x16x32_bf16 v[224:227], v[56:59], v[212:215], 0
    v_fma_f32 v79, v79, v241, v253
    v_fma_f32 v246, v246, v241, v253
    v_mfma_f32_16x16x32_bf16 v[224:227], v[60:63], v[216:219], v[224:227]
    ds_read_u16 v130, v14
    ds_read_b128 v[184:187], v19 offset:448
    v_mfma_f32_16x16x32_bf16 v[224:227], v[64:67], v[220:223], v[224:227]
    v_exp_f32 v68, v68
    v_exp_f32 v69, v69
    v_cvt_pk_bf16_f32 v144, v228, v229
    v_cvt_pk_bf16_f32 v145, v230, v231
    v_exp_f32 v70, v70
    v_exp_f32 v71, v71
    v_exp_f32 v72, v72
    v_exp_f32 v73, v73
    v_cvt_pk_bf16_f32 v124, v232, v233
    v_cvt_pk_bf16_f32 v125, v234, v235
    v_exp_f32 v74, v74
    v_exp_f32 v75, v75
    v_cvt_pk_bf16_f32 v126, v236, v237
    v_exp_f32 v76, v76
    v_cvt_pk_bf16_f32 v127, v238, v239
    v_exp_f32 v77, v77
    v_exp_f32 v78, v78
    v_cvt_pk_bf16_f32 v148, v224, v225
    v_cvt_pk_bf16_f32 v149, v226, v227
    v_exp_f32 v79, v79
    v_exp_f32 v246, v246
    ds_read_u16 v134, v14 offset:8
    ds_read_b128 v[212:215], v13
    ds_read_b128 v[216:219], v13 offset:64
    ds_read_u16 v138, v14 offset:64
    ds_read_b128 v[220:223], v13 offset:128
    ds_read_u16 v142, v14 offset:72
    ds_read_u16 v146, v14 offset:128
    v_mul_f32 v68, v68, v152
    v_mul_f32 v69, v69, v153
    v_mul_f32 v70, v70, v154
    v_mul_f32 v71, v71, v155
    v_mul_f32 v72, v72, v156
    v_mul_f32 v73, v73, v157
    v_mul_f32 v74, v74, v158
    v_mul_f32 v75, v75, v159
    ds_read_u16 v150, v14 offset:136
    v_mul_f32 v76, v76, v160
    v_mul_f32 v77, v77, v161
    v_mul_f32 v78, v78, v162
    v_mul_f32 v79, v79, v163
    v_mul_f32 v246, v246, v244
    v_mul_f32 v80, v80, v152
    s_waitcnt lgkmcnt(6)
    v_mfma_f32_4x4x4_16b_bf16 v[228:231], v[28:29], v[212:213], 0
    v_mul_f32 v81, v81, v153
    v_mfma_f32_4x4x4_16b_bf16 v[232:235], v[28:29], v[214:215], 0
    s_waitcnt lgkmcnt(5)
    v_mfma_f32_4x4x4_16b_bf16 v[236:239], v[28:29], v[216:217], 0
    v_mfma_f32_4x4x4_16b_bf16 v[224:227], v[28:29], v[218:219], 0
    v_mfma_f32_16x16x32_bf16 v[228:231], v[104:107], v[180:183], v[228:231]
    v_mul_f32 v82, v82, v154
    v_mul_f32 v83, v83, v155
    v_mfma_f32_16x16x32_bf16 v[228:231], v[128:131], v[184:187], v[228:231]
    v_mul_f32 v84, v84, v156
    v_mul_f32 v85, v85, v157
    v_mfma_f32_16x16x32_bf16 v[232:235], v[108:111], v[180:183], v[232:235]
    v_mfma_f32_16x16x32_bf16 v[232:235], v[132:135], v[184:187], v[232:235]
    v_cvt_pk_bf16_f32 v212, v228, v229
    v_cvt_pk_bf16_f32 v213, v230, v231
    v_mfma_f32_16x16x32_bf16 v[236:239], v[112:115], v[180:183], v[236:239]
    v_mul_f32 v86, v86, v158
    v_mul_f32 v87, v87, v159
    v_mfma_f32_16x16x32_bf16 v[224:227], v[116:119], v[180:183], v[224:227]
    v_cvt_pk_bf16_f32 v214, v232, v233
    v_cvt_pk_bf16_f32 v215, v234, v235
    s_waitcnt lgkmcnt(4)
    v_mfma_f32_16x16x32_bf16 v[236:239], v[136:139], v[184:187], v[236:239]
    v_mul_f32 v88, v88, v160
    v_mul_f32 v89, v89, v161
    s_waitcnt lgkmcnt(2)
    v_mfma_f32_16x16x32_bf16 v[224:227], v[140:143], v[184:187], v[224:227]
    v_mul_f32 v90, v90, v162
    v_mul_f32 v91, v91, v163
    v_max3_f32 v250, v80, v81, v247
    v_mfma_f32_4x4x4_16b_bf16 v[228:231], v[28:29], v[220:221], 0
    v_cvt_pk_bf16_f32 v216, v236, v237
    v_mfma_f32_4x4x4_16b_bf16 v[232:235], v[28:29], v[222:223], 0
    v_cvt_pk_bf16_f32 v217, v238, v239
    v_max3_f32 v251, v82, v83, v84
    v_mfma_f32_16x16x32_bf16 v[228:231], v[120:123], v[180:183], v[228:231]
    v_cvt_pk_bf16_f32 v218, v224, v225
    v_cvt_pk_bf16_f32 v219, v226, v227
    v_mfma_f32_16x16x32_bf16 v[232:235], v[124:127], v[180:183], v[232:235]
    v_cvt_pk_bf16_f32 v180, v68, v69
    v_cvt_pk_bf16_f32 v181, v70, v71
    s_waitcnt lgkmcnt(1)
    v_mfma_f32_16x16x32_bf16 v[228:231], v[144:147], v[184:187], v[228:231]
    v_cvt_pk_bf16_f32 v182, v72, v73
    v_cvt_pk_bf16_f32 v183, v74, v75
    s_waitcnt lgkmcnt(0)
    v_mfma_f32_16x16x32_bf16 v[232:235], v[148:151], v[184:187], v[232:235]
    v_cvt_pk_bf16_f32 v184, v76, v77
    v_cvt_pk_bf16_f32 v185, v78, v79
    v_mfma_f32_16x16x32_bf16 v[236:239], v[164:167], v[172:175], 0
    v_cvt_pk_bf16_f32 v186, v246, 0
    v_cvt_pk_bf16_f32 v220, v228, v229
    v_mfma_f32_16x16x32_bf16 v[236:239], v[168:171], v[176:179], v[236:239]
    v_cvt_pk_bf16_f32 v221, v230, v231
    v_max3_f32 v250, v250, v85, v86
    v_mfma_f32_16x16x32_bf16 v[224:227], v[104:107], v[172:175], 0
    v_max3_f32 v251, v251, v87, v88
    v_max3_f32 v250, v250, v89, v90
    v_mfma_f32_16x16x32_bf16 v[224:227], v[128:131], v[176:179], v[224:227]
    v_max3_f32 v250, v250, v251, v91
    v_cvt_pk_bf16_f32 v222, v232, v233
    v_mfma_f32_16x16x32_bf16 v[228:231], v[108:111], v[172:175], 0
    v_mov_b32 v251, v250
    v_cvt_pk_bf16_f32 v223, v234, v235
    v_mfma_f32_16x16x32_bf16 v[228:231], v[132:135], v[176:179], v[228:231]
    buffer_store_dwordx4 v[212:215], v23, s[8:11], s60 offen sc0 sc1
    buffer_store_dwordx4 v[216:219], v23, s[8:11], s60 offen offset:64 sc0 sc1
    buffer_store_dwordx4 v[220:223], v23, s[8:11], s60 offen offset:128 sc0 sc1
    v_permlane32_swap_b32 v250, v251
    v_rcp_f32 v255, v236
    v_max_f32 v250, v250, v251
    v_mul_f32 v224, v224, v255
    v_mov_b32 v251, v250
    v_mfma_f32_16x16x32_bf16 v[232:235], v[112:115], v[172:175], 0
    v_permlane16_swap_b32 v250, v251
    v_mfma_f32_16x16x32_bf16 v[232:235], v[136:139], v[176:179], v[232:235]
    v_max_f32 v250, v250, v251
    v_mul_f32 v225, v225, v255
    v_mul_f32_e64 v250, -v250, v242
    v_mul_f32 v226, v226, v255
    v_fma_f32 v80, v80, v242, v250
    v_fma_f32 v81, v81, v242, v250
    v_fma_f32 v82, v82, v242, v250
    v_fma_f32 v83, v83, v242, v250
    v_fma_f32 v84, v84, v242, v250
    v_mfma_f32_16x16x32_bf16 v[236:239], v[116:119], v[172:175], 0
    v_fma_f32 v85, v85, v242, v250
    v_mul_f32 v227, v227, v255
    v_fma_f32 v86, v86, v242, v250
    v_fma_f32 v87, v87, v242, v250
    v_mfma_f32_4x4x4_16b_bf16 v[224:227], v[28:29], v[32:33], v[224:227]
    v_fma_f32 v88, v88, v242, v250
    v_fma_f32 v89, v89, v242, v250
    v_mfma_f32_16x16x32_bf16 v[236:239], v[140:143], v[176:179], v[236:239]
    v_fma_f32 v90, v90, v242, v250
    v_cvt_pk_bf16_f32 v92, v224, v225
    v_cvt_pk_bf16_f32 v93, v226, v227
    v_fma_f32 v91, v91, v242, v250
    v_fma_f32 v247, v247, v242, v250
    v_mul_f32 v228, v228, v255
    v_exp_f32 v80, v80
    v_mul_f32 v229, v229, v255
    v_mul_f32 v230, v230, v255
    v_mfma_f32_16x16x32_bf16 v[224:227], v[120:123], v[172:175], 0
    v_mul_f32 v231, v231, v255
    v_exp_f32 v81, v81
    s_nop 0
    v_mfma_f32_4x4x4_16b_bf16 v[228:231], v[28:29], v[34:35], v[228:231]
    v_exp_f32 v82, v82
    v_exp_f32 v83, v83
    v_exp_f32 v84, v84
    s_nop 1
    v_cvt_pk_bf16_f32 v94, v228, v229
    v_mfma_f32_16x16x32_bf16 v[224:227], v[144:147], v[176:179], v[224:227]
    v_cvt_pk_bf16_f32 v95, v230, v231
    v_mul_f32 v232, v232, v255
    v_exp_f32 v85, v85
    v_mul_f32 v233, v233, v255
    v_mul_f32 v234, v234, v255
    v_mul_f32 v235, v235, v255
    v_exp_f32 v86, v86
    s_nop 0
    v_mfma_f32_4x4x4_16b_bf16 v[232:235], v[28:29], v[36:37], v[232:235]
    v_exp_f32 v87, v87
    v_exp_f32 v88, v88
    ds_write_b128 v21, v[92:95]
    v_mfma_f32_16x16x32_bf16 v[228:231], v[124:127], v[172:175], 0
    v_cvt_pk_bf16_f32 v96, v232, v233
    v_cvt_pk_bf16_f32 v97, v234, v235
    v_mfma_f32_16x16x32_bf16 v[228:231], v[148:151], v[176:179], v[228:231]
    v_exp_f32 v89, v89
    v_mul_f32 v236, v236, v255
    v_mul_f32 v237, v237, v255
    v_mul_f32 v238, v238, v255
    v_exp_f32 v90, v90
    v_mul_f32 v239, v239, v255
    v_exp_f32 v91, v91
    s_nop 0
    v_mfma_f32_4x4x4_16b_bf16 v[236:239], v[28:29], v[38:39], v[236:239]
    v_exp_f32 v247, v247
    v_mul_f32 v80, v80, v152
    v_mul_f32 v81, v81, v153
    v_mul_f32 v82, v82, v154
    s_nop 0
    v_cvt_pk_bf16_f32 v98, v236, v237
    v_cvt_pk_bf16_f32 v99, v238, v239
    v_mul_f32 v224, v224, v255
    v_mul_f32 v225, v225, v255
    v_mul_f32 v83, v83, v155
    v_mul_f32 v226, v226, v255
    v_mul_f32 v84, v84, v156
    v_mul_f32 v227, v227, v255
    v_mul_f32 v85, v85, v157
    v_mul_f32 v86, v86, v158
    v_mfma_f32_4x4x4_16b_bf16 v[224:227], v[28:29], v[40:41], v[224:227]
    v_mul_f32 v87, v87, v159
    v_mul_f32 v88, v88, v160
    v_mul_f32 v89, v89, v161
    v_mul_f32 v90, v90, v162
    ds_write_b128 v21, v[96:99] offset:64
    v_cvt_pk_bf16_f32 v100, v224, v225
    v_cvt_pk_bf16_f32 v101, v226, v227
    v_mul_f32 v91, v91, v163
    v_mul_f32 v228, v228, v255
    v_mul_f32 v247, v247, v244
    v_mul_f32 v229, v229, v255
    v_mul_f32 v230, v230, v255
    v_cvt_pk_bf16_f32 v172, v80, v81
    v_mul_f32 v231, v231, v255
    v_cvt_pk_bf16_f32 v173, v82, v83
    v_cvt_pk_bf16_f32 v174, v84, v85
    v_mfma_f32_4x4x4_16b_bf16 v[228:231], v[28:29], v[42:43], v[228:231]
    v_cvt_pk_bf16_f32 v175, v86, v87
    v_cvt_pk_bf16_f32 v176, v88, v89
    v_cvt_pk_bf16_f32 v177, v90, v91
    v_cvt_pk_bf16_f32 v178, v247, 0
    v_add_u32 v12, v12, v25
    v_cvt_pk_bf16_f32 v102, v228, v229
    v_cvt_pk_bf16_f32 v103, v230, v231
    v_add_u32 v13, 0xc0, v13
    v_add_u32 v14, 0xc0, v14
    v_add_u32 v16, v16, v26
    v_add_u32 v10, s55, v10
    s_add_u32 s61, s61, s55
    s_sub_u32 s55, 0, s55
    ds_write_b128 v21, v[100:103] offset:128
    ds_read_b128 v[92:95], v22
    ds_read_b128 v[96:99], v22 offset:1024
    ds_read_b128 v[100:103], v22 offset:2048
    s_waitcnt lgkmcnt(2)
    buffer_store_dwordx4 v[92:95], v1, s[8:11], s60 offen sc0 sc1
    s_waitcnt lgkmcnt(1)
    buffer_store_dwordx4 v[96:99], v2, s[8:11], s60 offen sc0 sc1
    s_waitcnt lgkmcnt(0)
    buffer_store_dwordx4 v[100:103], v3, s[8:11], s60 offen sc0 sc1
    s_waitcnt vmcnt(6)
    s_add_u32 s39, s39, 1
    s_waitcnt lgkmcnt(0)
L_Sloop:
    s_barrier
    v_mfma_f32_16x16x32_bf16 v[224:227], v[164:167], v[180:183], 0
    v_mfma_f32_16x16x32_bf16 v[236:239], v[112:115], v[180:183], 0
    ds_read_b128 v[192:195], v12 offset:64
    ds_read_b128 v[208:211], v11 offset:2048
    v_mfma_f32_16x16x32_bf16 v[232:235], v[108:111], v[180:183], 0
    ds_read_b128 v[188:191], v12
    v_mfma_f32_16x16x32_bf16 v[228:231], v[104:107], v[180:183], 0
    ds_read_b128 v[216:219], v11 offset:4096
    v_mfma_f32_16x16x32_bf16 v[228:231], v[128:131], v[184:187], v[228:231]
    s_add_u32 s58, s39, 2
    v_mfma_f32_16x16x32_bf16 v[224:227], v[168:171], v[184:187], v[224:227]
    ds_read_b128 v[196:199], v12 offset:128
    v_mfma_f32_16x16x32_bf16 v[236:239], v[136:139], v[184:187], v[236:239]
    ds_read_b128 v[212:215], v11 offset:3072
    v_mfma_f32_16x16x32_bf16 v[232:235], v[132:135], v[184:187], v[232:235]
    v_rcp_f32 v255, v224
    v_mfma_f32_16x16x32_bf16 v[224:227], v[116:119], v[180:183], 0
    s_setprio 1
    v_mul_f32 v229, v229, v255
    v_mul_f32 v230, v230, v255
    v_mul_f32 v231, v231, v255
    v_mul_f32 v234, v234, v255
    v_mfma_f32_16x16x32_bf16 v[224:227], v[140:143], v[184:187], v[224:227]
    s_mul_i32 s69, s58, s41
    v_mul_f32 v228, v228, v255
    v_mul_f32 v235, v235, v255
    v_mul_f32 v233, v233, v255
    v_mul_f32 v232, v232, v255
    v_mfma_f32_4x4x4_16b_bf16 v[228:231], v[28:29], v[44:45], v[228:231]
    v_mfma_f32_4x4x4_16b_bf16 v[232:235], v[28:29], v[46:47], v[232:235]
    v_mul_f32 v226, v226, v255
    v_mul_f32 v239, v239, v255
    ds_read_b128 v[44:47], v10 offset:3072
    ds_read_b32 v30, v16 offset:256
    v_cvt_pk_bf16_f32 v69, v230, v231
    v_mul_f32 v224, v224, v255
    v_cvt_pk_bf16_f32 v68, v228, v229
    v_mul_f32 v225, v225, v255
    v_mfma_f32_16x16x32_bf16 v[228:231], v[120:123], v[180:183], 0
    v_cvt_pk_bf16_f32 v70, v232, v233
    v_mfma_f32_16x16x32_bf16 v[228:231], v[144:147], v[184:187], v[228:231]
    v_mul_f32 v237, v237, v255
    v_cvt_pk_bf16_f32 v71, v234, v235
    v_mfma_f32_16x16x32_bf16 v[232:235], v[124:127], v[180:183], 0
    s_add_u32 s69, s69, s40
    v_mul_f32 v236, v236, v255
    v_mul_f32 v238, v238, v255
    v_mfma_f32_16x16x32_bf16 v[232:235], v[148:151], v[184:187], v[232:235]
    v_mul_f32 v228, v228, v255
    v_mul_f32 v227, v227, v255
    ds_read_b128 v[32:35], v10
    v_mul_f32 v230, v230, v255
    v_mul_f32 v229, v229, v255
    v_mfma_f32_4x4x4_16b_bf16 v[224:227], v[28:29], v[50:51], v[224:227]
    v_mul_f32 v231, v231, v255
    v_mfma_f32_4x4x4_16b_bf16 v[236:239], v[28:29], v[48:49], v[236:239]
    v_mul_f32 v233, v233, v255
    v_mfma_f32_4x4x4_16b_bf16 v[228:231], v[28:29], v[52:53], v[228:231]
    v_mul_f32 v232, v232, v255
    v_cvt_pk_bf16_f32 v75, v226, v227
    s_nop 0
    v_cvt_pk_bf16_f32 v73, v238, v239
    v_cvt_pk_bf16_f32 v72, v236, v237
    v_mfma_f32_16x16x32_bf16 v[236:239], v[164:167], v[172:175], 0
    v_cvt_pk_bf16_f32 v76, v228, v229
    v_cvt_pk_bf16_f32 v74, v224, v225
    v_mfma_f32_16x16x32_bf16 v[236:239], v[168:171], v[176:179], v[236:239]
    ds_read_b128 v[200:203], v11
    v_cvt_pk_bf16_f32 v77, v230, v231
    v_mfma_f32_16x16x32_bf16 v[224:227], v[104:107], v[172:175], 0
    ds_write_b128 v21, v[68:71]
    v_mfma_f32_16x16x32_bf16 v[224:227], v[128:131], v[176:179], v[224:227]
    v_mfma_f32_16x16x32_bf16 v[228:231], v[108:111], v[172:175], 0
    v_rcp_f32 v252, v236
    v_mfma_f32_16x16x32_bf16 v[228:231], v[132:135], v[176:179], v[228:231]
    v_mul_f32 v235, v235, v255
    v_mul_f32 v234, v234, v255
    v_mfma_f32_16x16x32_bf16 v[236:239], v[116:119], v[172:175], 0
    v_mul_f32 v224, v224, v252
    v_mul_f32 v225, v225, v252
    ds_write_b128 v21, v[72:75] offset:64
    v_mul_f32 v227, v227, v252
    s_mul_hi_u32 s56, s69, 0x4bda130
    v_mfma_f32_16x16x32_bf16 v[236:239], v[140:143], v[176:179], v[236:239]
    v_mul_f32 v229, v229, v252
    v_mul_f32 v230, v230, v252
    v_mul_f32 v231, v231, v252
    v_mul_f32 v228, v228, v252
    v_mfma_f32_4x4x4_16b_bf16 v[232:235], v[28:29], v[54:55], v[232:235]
    s_mul_i32 s57, s56, 54
    v_mul_f32 v226, v226, v252
    v_mfma_f32_4x4x4_16b_bf16 v[228:231], v[28:29], v[58:59], v[228:231]
    v_mfma_f32_4x4x4_16b_bf16 v[224:227], v[28:29], v[56:57], v[224:227]
    v_cvt_pk_bf16_f32 v78, v232, v233
    v_cvt_pk_bf16_f32 v79, v234, v235
    ds_write_b128 v21, v[76:79] offset:128
    s_nop 1
    v_cvt_pk_bf16_f32 v80, v224, v225
    v_cvt_pk_bf16_f32 v81, v226, v227
    ds_read_b128 v[52:55], v10 offset:3200
    ds_read_b128 v[36:39], v10 offset:64
    ds_read_b128 v[68:71], v22
    v_mfma_f32_16x16x32_bf16 v[224:227], v[120:123], v[172:175], 0
    v_cvt_pk_bf16_f32 v83, v230, v231
    v_cvt_pk_bf16_f32 v82, v228, v229
    v_mfma_f32_16x16x32_bf16 v[228:231], v[124:127], v[172:175], 0
    v_mul_f32 v239, v239, v252
    v_mfma_f32_16x16x32_bf16 v[228:231], v[148:151], v[176:179], v[228:231]
    v_mul_f32 v236, v236, v252
    v_mul_f32 v238, v238, v252
    ds_read_b128 v[56:59], v10 offset:6144
    ds_read_b128 v[76:79], v22 offset:2048
    v_mfma_f32_16x16x32_bf16 v[224:227], v[144:147], v[176:179], v[224:227]
    ds_read_b128 v[48:51], v10 offset:3136
    v_mfma_f32_16x16x32_bf16 v[232:235], v[112:115], v[172:175], 0
    v_mov_b32 v254, 0xff800000
    v_mul_f32 v228, v228, v252
    v_mfma_f32_16x16x32_bf16 v[232:235], v[136:139], v[176:179], v[232:235]
    s_mul_i32 s56, s56, 0x7c080
    v_mul_f32 v227, v227, v252
    v_mul_f32 v229, v229, v252
    ds_read_b128 v[40:43], v10 offset:128
    ds_read_b128 v[72:75], v22 offset:1024
    v_mul_f32 v225, v225, v252
    v_mul_f32 v237, v237, v252
    v_mul_f32 v224, v224, v252
    v_mul_f32 v234, v234, v252
    s_waitcnt lgkmcnt(5)
    buffer_store_dwordx4 v[68:71], v4, s[8:11], s60 offen sc0 sc1
    v_mul_f32 v233, v233, v252
    v_mul_f32 v230, v230, v252
    s_sub_u32 s57, s69, s57
    s_mul_i32 s57, s57, 0x540
    v_mul_f32 v231, v231, v252
    v_mul_f32 v232, v232, v252
    v_mfma_f32_4x4x4_16b_bf16 v[236:239], v[28:29], v[62:63], v[236:239]
    v_mul_f32 v226, v226, v252
    v_mfma_f32_4x4x4_16b_bf16 v[228:231], v[28:29], v[66:67], v[228:231]
    v_mul_f32 v235, v235, v252
    v_mfma_f32_4x4x4_16b_bf16 v[224:227], v[28:29], v[64:65], v[224:227]
    s_add_u32 m0, s61, 0
    v_mfma_f32_4x4x4_16b_bf16 v[232:235], v[28:29], v[60:61], v[232:235]
    v_cvt_pk_bf16_f32 v87, v238, v239
    v_cvt_pk_bf16_f32 v86, v236, v237
    v_mfma_f32_16x16x32_bf16 v[236:239], v[188:191], v[32:35], 0
    v_cvt_pk_bf16_f32 v88, v224, v225
    v_cvt_pk_bf16_f32 v91, v230, v231
    v_mfma_f32_16x16x32_bf16 v[236:239], v[192:195], v[36:39], v[236:239]
    v_cvt_pk_bf16_f32 v85, v234, v235
    v_cvt_pk_bf16_f32 v84, v232, v233
    v_mfma_f32_16x16x32_bf16 v[232:235], v[32:35], v[32:35], 0
    ds_read_b128 v[204:207], v11 offset:1024
    v_cvt_pk_bf16_f32 v89, v226, v227
    v_mfma_f32_16x16x32_bf16 v[224:227], v[44:47], v[44:47], 0
    s_mov_b32 s3, s59
    ds_read_b128 v[64:67], v10 offset:6272
    s_waitcnt lgkmcnt(4)
    v_mfma_f32_16x16x32_bf16 v[224:227], v[48:51], v[48:51], v[224:227]
    ds_read_b128 v[60:63], v10 offset:6208
    v_cvt_pk_bf16_f32 v90, v228, v229
    v_mfma_f32_16x16x32_bf16 v[228:231], v[188:191], v[44:47], 0
    s_waitcnt lgkmcnt(3)
    buffer_store_dwordx4 v[72:75], v5, s[8:11], s60 offen sc0 sc1
    v_mfma_f32_16x16x32_bf16 v[228:231], v[192:195], v[48:51], v[228:231]
    ds_write_b128 v21, v[80:83]
    v_mfma_f32_16x16x32_bf16 v[232:235], v[36:39], v[36:39], v[232:235]
    s_add_u32 s59, s56, s57
    s_add_u32 s59, s59, s54
    v_mfma_f32_16x16x32_bf16 v[232:235], v[40:43], v[40:43], v[232:235]
    s_cmp_lt_u32 s58, s38
    s_cselect_b32 s59, s59, 0x68a6c00
    v_mfma_f32_16x16x32_bf16 v[224:227], v[52:55], v[52:55], v[224:227]
    ds_write_b128 v21, v[84:87] offset:64
    ds_read_b128 v[220:223], v11 offset:5120
    v_mfma_f32_16x16x32_bf16 v[236:239], v[196:199], v[40:43], v[236:239]
    s_mov_b64 exec, s[42:43]
    ds_write_b128 v15, v[232:235]
    s_mov_b64 exec, -1
    v_mfma_f32_16x16x32_bf16 v[232:235], v[56:59], v[56:59], 0
    s_waitcnt lgkmcnt(4)
    v_mfma_f32_16x16x32_bf16 v[232:235], v[60:63], v[60:63], v[232:235]
    v_mov_b32_dpp v30, v236 quad_perm:[0,1,2,3] row_mask:0x1 bank_mask:0xf
    v_mfma_f32_16x16x32_bf16 v[232:235], v[64:67], v[64:67], v[232:235]
    v_mov_b32_dpp v27, v237 quad_perm:[0,1,2,3] row_mask:0x1 bank_mask:0xf
    v_mfma_f32_16x16x32_bf16 v[228:231], v[196:199], v[52:55], v[228:231]
    s_mov_b64 exec, s[42:43]
    ds_write_b128 v15, v[224:227] offset:256
    s_mov_b64 exec, -1
    buffer_load_dwordx4 v1, s[4:7], s59 offen lds
    v_mfma_f32_16x16x32_bf16 v[236:239], v[188:191], v[56:59], 0
    s_mov_b64 exec, s[42:43]
    ds_write_b128 v15, v[232:235] offset:512
    s_mov_b64 exec, -1
    v_mfma_f32_16x16x32_bf16 v[236:239], v[192:195], v[60:63], v[236:239]
    ds_read_b32 v248, v16
    ds_read_b128 v[120:123], v13 offset:64
    v_mfma_f32_16x16x32_bf16 v[236:239], v[196:199], v[64:67], v[236:239]
    v_mfma_f32_16x16x32_bf16 v[232:235], v[200:203], v[56:59], 0
    v_mov_b32_dpp v27, v229 quad_perm:[0,1,2,3] row_mask:0x2 bank_mask:0xf
    v_mov_b32_dpp v30, v228 quad_perm:[0,1,2,3] row_mask:0x2 bank_mask:0xf
    v_mfma_f32_16x16x32_bf16 v[228:231], v[200:203], v[44:47], 0
    v_mov_b32_dpp v27, v237 quad_perm:[0,1,2,3] row_mask:0x4 bank_mask:0xf
    v_mul_f32 v253, v27, v27
    v_mfma_f32_16x16x32_bf16 v[228:231], v[204:207], v[48:51], v[228:231]
    ds_write_b128 v21, v[88:91] offset:128
    s_add_u32 m0, s61, 0x400
    v_mfma_f32_16x16x32_bf16 v[224:227], v[200:203], v[32:35], 0
    ds_read_b128 v[200:203], v11 offset:6144
    ds_read_b128 v[80:83], v22
    v_mfma_f32_16x16x32_bf16 v[224:227], v[204:207], v[36:39], v[224:227]
    buffer_load_dwordx4 v2, s[4:7], s59 offen lds
    v_mfma_f32_16x16x32_bf16 v[224:227], v[208:211], v[40:43], v[224:227]
    s_add_u32 m0, s61, 0x800
    v_mfma_f32_16x16x32_bf16 v[228:231], v[208:211], v[52:55], v[228:231]
    s_waitcnt lgkmcnt(4)
    v_fmamk_f32 v248, v253, 0xbc2aaaab, v248
    v_mov_b32_dpp v30, v236 quad_perm:[0,1,2,3] row_mask:0x4 bank_mask:0xf
    v_mfma_f32_16x16x32_bf16 v[232:235], v[204:207], v[60:63], v[232:235]
    v_cvt_pk_bf16_f32 v68, v224, v225
    v_cvt_pk_bf16_f32 v69, v226, v227
    v_mfma_f32_16x16x32_bf16 v[224:227], v[212:215], v[44:47], 0
    v_max_f32 v248, 0, v248
    v_add_f32 v248, 0x3a7ba882, v248
    v_mfma_f32_16x16x32_bf16 v[232:235], v[208:211], v[64:67], v[232:235]
    buffer_load_dwordx4 v3, s[4:7], s59 offen lds
    v_mfma_f32_16x16x32_bf16 v[224:227], v[216:219], v[48:51], v[224:227]
    v_rsq_f32 v249, v248
    v_mfma_f32_16x16x32_bf16 v[236:239], v[212:215], v[32:35], 0
    ds_read_b128 v[204:207], v11 offset:7168
    v_cvt_pk_bf16_f32 v93, v234, v235
    v_mfma_f32_16x16x32_bf16 v[236:239], v[216:219], v[36:39], v[236:239]
    s_waitcnt lgkmcnt(1)
    buffer_store_dwordx4 v[80:83], v7, s[8:11], s60 offen sc0 sc1
    v_mfma_f32_16x16x32_bf16 v[236:239], v[220:223], v[40:43], v[236:239]
    v_mul_f32 v248, v248, v249
    v_cvt_pk_bf16_f32 v92, v232, v233
    ds_read_b128 v[84:87], v22 offset:1024
    ds_read_b128 v[208:211], v11 offset:8192
    v_mfma_f32_16x16x32_bf16 v[224:227], v[220:223], v[52:55], v[224:227]
    v_cvt_pk_bf16_f32 v80, v228, v229
    v_cvt_pk_bf16_f32 v81, v230, v231
    v_mfma_f32_16x16x32_bf16 v[228:231], v[212:215], v[56:59], 0
    ds_write_b32 v17, v249
    v_mfma_f32_16x16x32_bf16 v[228:231], v[216:219], v[60:63], v[228:231]
    v_cvt_pk_bf16_f32 v82, v224, v225
    v_cvt_pk_bf16_f32 v70, v236, v237
    v_mfma_f32_16x16x32_bf16 v[228:231], v[220:223], v[64:67], v[228:231]
    v_cvt_pk_bf16_f32 v248, v248, v248
    v_cvt_pk_bf16_f32 v71, v238, v239
    v_mfma_f32_16x16x32_bf16 v[236:239], v[200:203], v[44:47], 0
    ds_read_b128 v[220:223], v11 offset:11264
    v_cvt_pk_bf16_f32 v83, v226, v227
    v_mfma_f32_16x16x32_bf16 v[224:227], v[200:203], v[56:59], 0
    ds_write_b16 v18, v248
    v_mfma_f32_16x16x32_bf16 v[188:191], v[32:35], v[68:71], 0
    s_add_u32 m0, s61, 0xc00
    ds_read_b128 v[164:167], v19 offset:256
    ds_read_b128 v[216:219], v11 offset:10240
    s_waitcnt lgkmcnt(6)
    buffer_store_dwordx4 v[84:87], v8, s[8:11], s60 offen sc0 sc1
    ds_read_b32 v243, v19 offset:192
    ds_read_b128 v[212:215], v11 offset:9216
    v_mfma_f32_16x16x32_bf16 v[232:235], v[200:203], v[32:35], 0
    ds_read_b128 v[88:91], v22 offset:2048
    v_mfma_f32_16x16x32_bf16 v[224:227], v[204:207], v[60:63], v[224:227]
    s_waitcnt lgkmcnt(8)
    v_mfma_f32_16x16x32_bf16 v[224:227], v[208:211], v[64:67], v[224:227]
    v_mul_f32 v30, v30, v249
    v_mfma_f32_16x16x32_bf16 v[236:239], v[204:207], v[48:51], v[236:239]
    ds_read_b128 v[124:127], v13 offset:128
    ds_read_b128 v[116:119], v13
    v_mfma_f32_16x16x32_bf16 v[232:235], v[204:207], v[36:39], v[232:235]
    ds_read_b128 v[204:207], v11 offset:13312
    v_cvt_pk_bf16_f32 v97, v226, v227
    v_mfma_f32_16x16x32_bf16 v[232:235], v[208:211], v[40:43], v[232:235]
    ds_read_b128 v[200:203], v11 offset:12288
    v_cvt_pk_bf16_f32 v95, v230, v231
    v_mfma_f32_16x16x32_bf16 v[236:239], v[208:211], v[52:55], v[236:239]
    s_waitcnt lgkmcnt(6)
    v_mul_f32 v30, v30, v243
    v_cndmask_b32_e64 v30, v254, v30, s[52:53]
    v_mfma_f32_16x16x32_bf16 v[192:195], v[44:47], v[68:71], 0
    v_cvt_pk_bf16_f32 v94, v228, v229
    s_waitcnt lgkmcnt(5)
    v_mfma_f32_16x16x32_bf16 v[228:231], v[212:215], v[32:35], 0
    v_mov_b32 v253, v30
    v_cvt_pk_bf16_f32 v72, v232, v233
    v_mfma_f32_16x16x32_bf16 v[228:231], v[216:219], v[36:39], v[228:231]
    v_max_f32_dpp v253, v253, v253 row_ror:8 row_mask:0xf bank_mask:0xf
    v_cvt_pk_bf16_f32 v73, v234, v235
    v_mfma_f32_16x16x32_bf16 v[232:235], v[212:215], v[44:47], 0
    buffer_store_dwordx4 v[76:79], v6, s[8:11], s60 offen sc0 sc1
    v_mfma_f32_16x16x32_bf16 v[232:235], v[216:219], v[48:51], v[232:235]
    v_cvt_pk_bf16_f32 v85, v238, v239
    v_max_f32_dpp v253, v253, v253 row_ror:4 row_mask:0xf bank_mask:0xf
    v_mfma_f32_16x16x32_bf16 v[232:235], v[220:223], v[52:55], v[232:235]
    v_max_f32_dpp v253, v253, v253 row_ror:2 row_mask:0xf bank_mask:0xf
    v_add_u32 v16, v16, v26
    v_mfma_f32_16x16x32_bf16 v[228:231], v[220:223], v[40:43], v[228:231]
    v_cvt_pk_bf16_f32 v96, v224, v225
    s_waitcnt lgkmcnt(0)
    v_mfma_f32_16x16x32_bf16 v[224:227], v[200:203], v[32:35], 0
    v_cvt_pk_bf16_f32 v86, v232, v233
    v_cvt_pk_bf16_f32 v84, v236, v237
    v_mfma_f32_16x16x32_bf16 v[236:239], v[212:215], v[56:59], 0
    ds_read_b128 v[208:211], v11 offset:14336
    v_max_f32_dpp v253, v253, v253 row_ror:1 row_mask:0xf bank_mask:0xf
    v_mfma_f32_16x16x32_bf16 v[236:239], v[216:219], v[60:63], v[236:239]
    v_cvt_pk_bf16_f32 v87, v234, v235
    v_mov_b32 v254, v253
    v_mfma_f32_16x16x32_bf16 v[224:227], v[204:207], v[36:39], v[224:227]
    v_permlane32_swap_b32 v253, v254
    ds_read_b128 v[216:219], v11 offset:16384
    ds_read_b128 v[152:155], v19
    ds_read_b128 v[212:215], v11 offset:15360
    ds_read_b128 v[156:159], v19 offset:64
    v_mfma_f32_16x16x32_bf16 v[236:239], v[220:223], v[64:67], v[236:239]
    ds_read_b32 v240, v20
    v_cvt_pk_bf16_f32 v74, v228, v229
    ds_read_u16 v138, v14 offset:64
    ds_read_b128 v[220:223], v11 offset:17408
    v_max_f32 v253, v253, v254
    v_cvt_pk_bf16_f32 v75, v230, v231
    v_mfma_f32_16x16x32_bf16 v[232:235], v[200:203], v[56:59], 0
    v_mfma_f32_16x16x32_bf16 v[188:191], v[36:39], v[72:75], v[188:191]
    v_cvt_pk_bf16_f32 v99, v238, v239
    v_cvt_pk_bf16_f32 v98, v236, v237
    v_mfma_f32_16x16x32_bf16 v[228:231], v[200:203], v[44:47], 0
    ds_read_b128 v[200:203], v11 offset:18432
    s_waitcnt lgkmcnt(8)
    v_mfma_f32_16x16x32_bf16 v[224:227], v[208:211], v[40:43], v[224:227]
    ds_read_b128 v[160:163], v19 offset:128
    v_mov_b32 v254, v253
    v_mfma_f32_16x16x32_bf16 v[232:235], v[204:207], v[60:63], v[232:235]
    buffer_store_dwordx4 v[88:91], v9, s[8:11], s60 offen sc0 sc1
    s_waitcnt lgkmcnt(6)
    v_mfma_f32_16x16x32_bf16 v[236:239], v[212:215], v[32:35], 0
    buffer_load_dwordx4 v4, s[4:7], s59 offen lds
    v_mfma_f32_16x16x32_bf16 v[228:231], v[204:207], v[48:51], v[228:231]
    v_cvt_pk_bf16_f32 v76, v224, v225
    s_add_u32 m0, s61, 0x1000
    v_mfma_f32_16x16x32_bf16 v[236:239], v[216:219], v[36:39], v[236:239]
    v_mul_f32 v244, 0x3e800000, v243
    s_waitcnt lgkmcnt(2)
    v_mfma_f32_16x16x32_bf16 v[236:239], v[220:223], v[40:43], v[236:239]
    v_cvt_pk_bf16_f32 v77, v226, v227
    v_mfma_f32_16x16x32_bf16 v[224:227], v[212:215], v[44:47], 0
    v_permlane16_swap_b32 v253, v254
    v_mfma_f32_16x16x32_bf16 v[232:235], v[208:211], v[64:67], v[232:235]
    v_max_f32 v253, v253, v254
    v_sub_f32 v30, v30, v253
    v_mfma_f32_16x16x32_bf16 v[196:199], v[56:59], v[68:71], 0
    v_exp_f32 v30, v30
    v_mfma_f32_16x16x32_bf16 v[196:199], v[60:63], v[72:75], v[196:199]
    v_cvt_pk_bf16_f32 v79, v238, v239
    v_cvt_pk_bf16_f32 v78, v236, v237
    v_mfma_f32_16x16x32_bf16 v[228:231], v[208:211], v[52:55], v[228:231]
    v_cvt_pk_bf16_f32 v100, v232, v233
    v_cvt_pk_bf16_f32 v101, v234, v235
    v_mfma_f32_16x16x32_bf16 v[196:199], v[64:67], v[76:79], v[196:199]
    v_mul_f32 v30, v30, v24
    v_mov_b32 v253, v30
    v_mfma_f32_16x16x32_bf16 v[224:227], v[216:219], v[48:51], v[224:227]
    v_cvt_pk_bf16_f32 v88, v228, v229
    v_add_f32_dpp v253, v253, v253 row_ror:8 row_mask:0xf bank_mask:0xf
    v_mfma_f32_16x16x32_bf16 v[192:195], v[48:51], v[72:75], v[192:195]
    s_waitcnt lgkmcnt(0)
    v_mul_f32 v196, v196, v160
    v_mul_f32 v197, v197, v161
    v_mfma_f32_16x16x32_bf16 v[192:195], v[52:55], v[76:79], v[192:195]
    v_mul_f32 v198, v198, v162
    v_add_f32_dpp v253, v253, v253 row_ror:4 row_mask:0xf bank_mask:0xf
    v_mfma_f32_16x16x32_bf16 v[188:191], v[40:43], v[76:79], v[188:191]
    buffer_load_dwordx4 v5, s[4:7], s59 offen lds
    v_mfma_f32_16x16x32_bf16 v[236:239], v[116:119], v[80:83], 0
    v_add_f32_dpp v253, v253, v253 row_ror:2 row_mask:0xf bank_mask:0xf
    v_mfma_f32_16x16x32_bf16 v[232:235], v[116:119], v[68:71], 0
    s_add_u32 m0, s61, 0x1400
    v_cvt_pk_bf16_f32 v89, v230, v231
    v_mul_f32 v190, v190, v154
    v_mfma_f32_16x16x32_bf16 v[68:71], v[32:35], v[80:83], 0
    v_add_f32_dpp v253, v253, v253 row_ror:1 row_mask:0xf bank_mask:0xf
    v_mov_b32 v254, v253
    v_mfma_f32_16x16x32_bf16 v[68:71], v[36:39], v[84:87], v[68:71]
    ds_read_b128 v[204:207], v11 offset:19456
    v_mfma_f32_16x16x32_bf16 v[224:227], v[220:223], v[52:55], v[224:227]
    buffer_load_dwordx4 v6, s[4:7], s59 offen lds
    v_mfma_f32_16x16x32_bf16 v[228:231], v[212:215], v[56:59], 0
    v_mul_f32 v189, v189, v153
    v_mul_f32 v191, v191, v155
    v_mfma_f32_16x16x32_bf16 v[232:235], v[120:123], v[72:75], v[232:235]
    ds_read_u16 v150, v14 offset:136
    v_cvt_pk_bf16_f32 v90, v224, v225
    v_mfma_f32_16x16x32_bf16 v[72:75], v[44:47], v[80:83], 0
    v_permlane32_swap_b32 v253, v254
    v_mfma_f32_16x16x32_bf16 v[228:231], v[216:219], v[60:63], v[228:231]
    ds_read_u16 v130, v14
    v_cvt_pk_bf16_f32 v91, v226, v227
    v_mfma_f32_16x16x32_bf16 v[228:231], v[220:223], v[64:67], v[228:231]
    v_mul_f32 v192, v192, v156
    v_mul_f32 v30, v30, v249
    v_mfma_f32_16x16x32_bf16 v[232:235], v[124:127], v[76:79], v[232:235]
    ds_read_b32 v241, v20 offset:64
    v_add_f32 v253, v253, v254
    v_mfma_f32_16x16x32_bf16 v[236:239], v[120:123], v[84:87], v[236:239]
    v_cvt_pk_bf16_f32 v102, v228, v229
    v_mul_f32 v195, v195, v159
    v_mfma_f32_16x16x32_bf16 v[236:239], v[124:127], v[88:91], v[236:239]
    v_max3_f32 v251, v190, v191, v192
    v_mul_f32 v245, v232, v243
    v_mfma_f32_16x16x32_bf16 v[76:79], v[56:59], v[80:83], 0
    v_mov_b32 v254, v253
    v_mul_f32 v193, v193, v157
    v_mfma_f32_16x16x32_bf16 v[76:79], v[60:63], v[84:87], v[76:79]
    ds_read_b128 v[220:223], v11 offset:23552
    v_max3_f32 v251, v251, v195, v196
    v_mfma_f32_16x16x32_bf16 v[224:227], v[116:119], v[92:95], 0
    v_mul_f32 v194, v194, v158
    v_mul_f32 v199, v199, v163
    v_mfma_f32_16x16x32_bf16 v[80:83], v[32:35], v[92:95], 0
    v_permlane16_swap_b32 v253, v254
    ds_read_b128 v[216:219], v11 offset:22528
    ds_read_b128 v[208:211], v11 offset:20480
    v_mfma_f32_16x16x32_bf16 v[68:71], v[40:43], v[88:91], v[68:71]
    v_mul_f32 v188, v188, v152
    v_max3_f32 v250, v188, v189, v245
    v_mfma_f32_16x16x32_bf16 v[76:79], v[64:67], v[88:91], v[76:79]
    v_max3_f32 v250, v250, v193, v194
    v_max3_f32 v250, v250, v197, v198
    v_mfma_f32_16x16x32_bf16 v[232:235], v[44:47], v[200:203], 0
    v_max3_f32 v250, v250, v251, v199
    v_cvt_pk_bf16_f32 v103, v230, v231
    v_mfma_f32_16x16x32_bf16 v[228:231], v[32:35], v[200:203], 0
    v_mul_f32 v68, v68, v152
    v_mov_b32 v251, v250
    s_nop 1
    v_permlane32_swap_b32 v250, v251
    v_mfma_f32_16x16x32_bf16 v[224:227], v[120:123], v[96:99], v[224:227]
    v_mul_f32 v246, v236, v243
    v_mul_f32 v76, v76, v160
    v_mfma_f32_16x16x32_bf16 v[224:227], v[124:127], v[100:103], v[224:227]
    v_max_f32 v250, v250, v251
    v_mov_b32 v251, v250
    v_mfma_f32_16x16x32_bf16 v[236:239], v[56:59], v[200:203], 0
    v_permlane16_swap_b32 v250, v251
    s_add_u32 m0, s61, 0x1800
    s_nop 0
    buffer_load_dwordx4 v7, s[4:7], s59 offen lds
    ds_read_u16 v142, v14 offset:72
    s_waitcnt lgkmcnt(7)
    v_mfma_f32_16x16x32_bf16 v[228:231], v[36:39], v[204:207], v[228:231]
    ds_read_b128 v[212:215], v11 offset:21504
    s_waitcnt lgkmcnt(2)
    v_mfma_f32_16x16x32_bf16 v[228:231], v[40:43], v[208:211], v[228:231]
    v_max_f32 v250, v250, v251
    v_add_f32 v253, v253, v254
    v_mfma_f32_16x16x32_bf16 v[232:235], v[48:51], v[204:207], v[232:235]
    v_rcp_f32 v253, v253
    v_mfma_f32_16x16x32_bf16 v[72:75], v[48:51], v[84:87], v[72:75]
    v_mul_f32_e64 v250, -v250, v240
    v_fma_f32 v194, v194, v240, v250
    v_mul_f32 v71, v71, v155
    v_cvt_pk_bf16_f32 v105, v230, v231
    v_mfma_f32_16x16x32_bf16 v[72:75], v[52:55], v[88:91], v[72:75]
    v_fma_f32 v199, v199, v240, v250
    v_fma_f32 v192, v192, v240, v250
    v_mfma_f32_16x16x32_bf16 v[232:235], v[52:55], v[208:211], v[232:235]
    v_fma_f32 v245, v245, v240, v250
    v_mul_f32 v30, v30, v253
    v_mfma_f32_16x16x32_bf16 v[236:239], v[60:63], v[204:207], v[236:239]
    ds_read_b128 v[204:207], v11 offset:25600
    v_cvt_pk_bf16_f32 v104, v228, v229
    v_mfma_f32_16x16x32_bf16 v[80:83], v[36:39], v[96:99], v[80:83]
    s_add_u32 m0, s61, 0x1c00
    v_exp_f32 v194, v194
    v_mfma_f32_16x16x32_bf16 v[236:239], v[64:67], v[208:211], v[236:239]
    v_cvt_pk_bf16_f32 v106, v232, v233
    s_waitcnt lgkmcnt(1)
    v_mfma_f32_16x16x32_bf16 v[228:231], v[44:47], v[212:215], 0
    v_cvt_pk_bf16_f32 v107, v234, v235
    v_fma_f32 v196, v196, v240, v250
    v_mfma_f32_16x16x32_bf16 v[228:231], v[48:51], v[216:219], v[228:231]
    v_mul_f32 v72, v72, v156
    v_mul_f32 v78, v78, v162
    v_mfma_f32_16x16x32_bf16 v[232:235], v[56:59], v[212:215], 0
    v_fma_f32 v198, v198, v240, v250
    v_mul_f32 v69, v69, v153
    v_mfma_f32_16x16x32_bf16 v[80:83], v[40:43], v[100:103], v[80:83]
    v_cvt_pk_bf16_f32 v129, v238, v239
    v_fma_f32 v197, v197, v240, v250
    ds_read_b128 v[208:211], v11 offset:26624
    ds_read_b128 v[200:203], v11 offset:24576
    v_mfma_f32_16x16x32_bf16 v[228:231], v[52:55], v[220:223], v[228:231]
    v_mul_f32 v75, v75, v159
    v_mul_f32 v247, v224, v243
    v_mfma_f32_16x16x32_bf16 v[84:87], v[44:47], v[92:95], 0
    v_mul_f32 v73, v73, v157
    v_mul_f32 v80, v80, v152
    v_mfma_f32_16x16x32_bf16 v[224:227], v[32:35], v[212:215], 0
    v_exp_f32 v196, v196
    v_mfma_f32_16x16x32_bf16 v[224:227], v[36:39], v[216:219], v[224:227]
    v_exp_f32 v192, v192
    v_cvt_pk_bf16_f32 v30, v30, v30
    v_mul_f32 v70, v70, v154
    v_mfma_f32_16x16x32_bf16 v[232:235], v[60:63], v[216:219], v[232:235]
    v_max3_f32 v254, v70, v71, v72
    v_mul_f32 v194, v194, v158
    v_mfma_f32_16x16x32_bf16 v[224:227], v[40:43], v[220:223], v[224:227]
    v_cvt_pk_bf16_f32 v128, v236, v237
    v_fma_f32 v190, v190, v240, v250
    v_mfma_f32_16x16x32_bf16 v[88:91], v[56:59], v[92:95], 0
    v_mul_f32 v79, v79, v163
    v_fma_f32 v195, v195, v240, v250
    v_mfma_f32_16x16x32_bf16 v[84:87], v[48:51], v[96:99], v[84:87]
    v_cvt_pk_bf16_f32 v111, v230, v231
    v_cvt_pk_bf16_f32 v109, v226, v227
    buffer_load_dwordx4 v8, s[4:7], s59 offen lds
    v_mfma_f32_16x16x32_bf16 v[84:87], v[52:55], v[100:103], v[84:87]
    ds_read_b128 v[216:219], v11 offset:28672
    v_mul_f32 v74, v74, v158
    v_fma_f32 v193, v193, v240, v250
    s_waitcnt lgkmcnt(1)
    v_mfma_f32_16x16x32_bf16 v[236:239], v[32:35], v[200:203], 0
    v_fma_f32 v189, v189, v240, v250
    v_cvt_pk_bf16_f32 v108, v224, v225
    v_mfma_f32_16x16x32_bf16 v[224:227], v[44:47], v[200:203], 0
    s_mov_b32 s60, s71
    v_max3_f32 v253, v68, v69, v246
    v_cvt_pk_bf16_f32 v110, v228, v229
    v_mfma_f32_16x16x32_bf16 v[232:235], v[64:67], v[220:223], v[232:235]
    ds_read_b128 v[220:223], v11 offset:29696
    v_mul_f32 v82, v82, v154
    v_mfma_f32_16x16x32_bf16 v[228:231], v[56:59], v[200:203], 0
    v_exp_f32 v193, v193
    v_mfma_f32_16x16x32_bf16 v[236:239], v[36:39], v[204:207], v[236:239]
    v_max3_f32 v253, v253, v73, v74
    v_mul_f32 v192, v192, v156
    v_mfma_f32_16x16x32_bf16 v[236:239], v[40:43], v[208:211], v[236:239]
    v_mul_f32 v87, v87, v159
    v_mul_f32 v77, v77, v161
    v_mfma_f32_16x16x32_bf16 v[228:231], v[60:63], v[204:207], v[228:231]
    v_exp_f32 v245, v245
    v_mfma_f32_16x16x32_bf16 v[88:91], v[60:63], v[96:99], v[88:91]
    v_cvt_pk_bf16_f32 v132, v232, v233
    v_max3_f32 v254, v254, v75, v76
    ds_read_b128 v[200:203], v11 offset:30720
    ds_read_b128 v[168:171], v19 offset:320
    s_mov_b32 s71, s3
    ds_read_b128 v[212:215], v11 offset:27648
    ds_read_u16 v134, v14 offset:8
    v_mfma_f32_16x16x32_bf16 v[228:231], v[64:67], v[208:211], v[228:231]
    v_cvt_pk_bf16_f32 v133, v234, v235
    v_fma_f32 v191, v191, v240, v250
    v_mul_f32 v81, v81, v153
    v_mfma_f32_16x16x32_bf16 v[88:91], v[64:67], v[100:103], v[88:91]
    v_exp_f32 v199, v199
    v_mfma_f32_16x16x32_bf16 v[224:227], v[48:51], v[204:207], v[224:227]
    v_cvt_pk_bf16_f32 v113, v238, v239
    v_cvt_pk_bf16_f32 v112, v236, v237
    v_cvt_pk_bf16_f32 v137, v230, v231
    v_fma_f32 v188, v188, v240, v250
    v_mfma_f32_16x16x32_bf16 v[224:227], v[52:55], v[208:211], v[224:227]
    ds_read_b128 v[208:211], v11 offset:32768
    s_waitcnt lgkmcnt(2)
    v_mfma_f32_16x16x32_bf16 v[236:239], v[44:47], v[212:215], 0
    v_exp_f32 v197, v197
    v_mfma_f32_16x16x32_bf16 v[236:239], v[48:51], v[216:219], v[236:239]
    v_cvt_pk_bf16_f32 v115, v226, v227
    v_mul_f32 v83, v83, v155
    v_mfma_f32_16x16x32_bf16 v[232:235], v[32:35], v[212:215], 0
    v_cvt_pk_bf16_f32 v114, v224, v225
    v_mul_f32 v245, v245, v244
    v_mfma_f32_16x16x32_bf16 v[224:227], v[56:59], v[212:215], 0
    v_cvt_pk_bf16_f32 v136, v228, v229
    v_mul_f32 v88, v88, v160
    ds_read_u16 v146, v14 offset:128
    ds_read_b32 v242, v20 offset:128
    ds_read_b128 v[204:207], v11 offset:31744
    ds_write_b16 v18, v30 offset:128
    v_mfma_f32_16x16x32_bf16 v[232:235], v[36:39], v[216:219], v[232:235]
    v_exp_f32 v191, v191
    v_mfma_f32_16x16x32_bf16 v[232:235], v[40:43], v[220:223], v[232:235]
    s_add_u32 m0, s61, 0x2000
    v_mul_f32 v197, v197, v161
    v_max3_f32 v253, v253, v77, v78
    v_mfma_f32_16x16x32_bf16 v[224:227], v[60:63], v[216:219], v[224:227]
    v_mul_f32 v86, v86, v158
    v_cvt_pk_bf16_f32 v178, v245, 0
    v_mfma_f32_16x16x32_bf16 v[228:231], v[32:35], v[200:203], 0
    v_cvt_pk_bf16_f32 v117, v234, v235
    v_cvt_pk_bf16_f32 v116, v232, v233
    v_mfma_f32_16x16x32_bf16 v[236:239], v[52:55], v[220:223], v[236:239]
    v_exp_f32 v195, v195
    v_mfma_f32_16x16x32_bf16 v[232:235], v[44:47], v[200:203], 0
    v_max3_f32 v253, v253, v254, v79
    v_mov_b32 v254, v253
    v_mfma_f32_16x16x32_bf16 v[224:227], v[64:67], v[220:223], v[224:227]
    v_mul_f32 v84, v84, v156
    v_max3_f32 v251, v82, v83, v84
    ds_read_b128 v[184:187], v19 offset:448
    ds_read_b128 v[216:219], v11 offset:34816
    ds_read_b128 v[220:223], v11 offset:35840
    s_waitcnt lgkmcnt(4)
    v_mfma_f32_16x16x32_bf16 v[232:235], v[48:51], v[204:207], v[232:235]
    ds_read_b128 v[212:215], v11 offset:33792
    v_cvt_pk_bf16_f32 v141, v226, v227
    buffer_load_dwordx4 v9, s[4:7], s59 offen lds
    v_mul_f32 v196, v196, v160
    v_cvt_pk_bf16_f32 v119, v238, v239
    v_mfma_f32_16x16x32_bf16 v[228:231], v[36:39], v[204:207], v[228:231]
    v_permlane32_swap_b32 v253, v254
    v_mfma_f32_16x16x32_bf16 v[228:231], v[40:43], v[208:211], v[228:231]
    v_cvt_pk_bf16_f32 v118, v236, v237
    v_cvt_pk_bf16_f32 v176, v196, v197
    v_mfma_f32_16x16x32_bf16 v[236:239], v[56:59], v[200:203], 0
    v_exp_f32 v198, v198
    v_mfma_f32_16x16x32_bf16 v[236:239], v[60:63], v[204:207], v[236:239]
    v_cvt_pk_bf16_f32 v140, v224, v225
    v_max_f32 v253, v253, v254
    v_mul_f32 v195, v195, v159
    v_cvt_pk_bf16_f32 v121, v230, v231
    v_mfma_f32_16x16x32_bf16 v[236:239], v[64:67], v[208:211], v[236:239]
    v_mov_b32 v254, v253
    v_cvt_pk_bf16_f32 v120, v228, v229
    v_mfma_f32_16x16x32_bf16 v[232:235], v[52:55], v[208:211], v[232:235]
    v_mul_f32 v85, v85, v157
    s_waitcnt lgkmcnt(0)
    v_mfma_f32_16x16x32_bf16 v[228:231], v[44:47], v[212:215], 0
    v_permlane16_swap_b32 v253, v254
    v_mfma_f32_16x16x32_bf16 v[228:231], v[48:51], v[216:219], v[228:231]
    v_cvt_pk_bf16_f32 v123, v234, v235
    v_add_u32 v10, s55, v10
    v_mfma_f32_16x16x32_bf16 v[228:231], v[52:55], v[220:223], v[228:231]
    v_cvt_pk_bf16_f32 v122, v232, v233
    v_cvt_pk_bf16_f32 v145, v238, v239
    v_mfma_f32_16x16x32_bf16 v[224:227], v[32:35], v[212:215], 0
    v_exp_f32 v188, v188
    v_mfma_f32_16x16x32_bf16 v[232:235], v[56:59], v[212:215], 0
    v_exp_f32 v190, v190
    v_mfma_f32_16x16x32_bf16 v[224:227], v[36:39], v[216:219], v[224:227]
    v_mul_f32 v89, v89, v161
    v_max_f32 v253, v253, v254
    v_max3_f32 v250, v80, v81, v247
    v_mul_f32_e64 v253, -v253, v241
    ds_read_b128 v[212:215], v13
    ds_read_b128 v[180:183], v19 offset:384
    v_mfma_f32_16x16x32_bf16 v[232:235], v[60:63], v[216:219], v[232:235]
    ds_read_b128 v[216:219], v13 offset:64
    v_cvt_pk_bf16_f32 v126, v228, v229
    v_exp_f32 v189, v189
    v_mfma_f32_16x16x32_bf16 v[232:235], v[64:67], v[220:223], v[232:235]
    v_fma_f32 v77, v77, v241, v253
    v_cvt_pk_bf16_f32 v127, v230, v231
    v_mfma_f32_16x16x32_bf16 v[224:227], v[40:43], v[220:223], v[224:227]
    v_fma_f32 v76, v76, v241, v253
    v_mul_f32 v199, v199, v163
    s_nop 0
    v_cvt_pk_bf16_f32 v148, v232, v233
    v_max3_f32 v250, v250, v85, v86
    v_fma_f32 v75, v75, v241, v253
    v_mul_f32 v198, v198, v162
    v_exp_f32 v75, v75
    ds_read_b128 v[220:223], v13 offset:128
    v_fma_f32 v68, v68, v241, v253
    v_cvt_pk_bf16_f32 v125, v226, v227
    v_cvt_pk_bf16_f32 v144, v236, v237
    v_fma_f32 v74, v74, v241, v253
    v_cvt_pk_bf16_f32 v149, v234, v235
    s_waitcnt lgkmcnt(1)
    v_mfma_f32_4x4x4_16b_bf16 v[232:235], v[28:29], v[218:219], 0
    v_fma_f32 v73, v73, v241, v253
    v_mfma_f32_4x4x4_16b_bf16 v[236:239], v[28:29], v[212:213], 0
    v_cvt_pk_bf16_f32 v124, v224, v225
    v_mfma_f32_4x4x4_16b_bf16 v[224:227], v[28:29], v[214:215], 0
    v_mul_f32 v75, v75, v159
    v_mfma_f32_4x4x4_16b_bf16 v[228:231], v[28:29], v[216:217], 0
    v_cvt_pk_bf16_f32 v177, v198, v199
    v_max3_f32 v251, v251, v87, v88
    v_mul_f32 v188, v188, v152
    v_add_u32 v14, 0xc0, v14
    v_mfma_f32_16x16x32_bf16 v[232:235], v[116:119], v[180:183], v[232:235]
    v_mul_f32 v193, v193, v157
    v_fma_f32 v69, v69, v241, v253
    v_mfma_f32_16x16x32_bf16 v[224:227], v[108:111], v[180:183], v[224:227]
    v_mul_f32 v190, v190, v154
    v_mul_f32 v91, v91, v163
    v_mul_f32 v90, v90, v162
    v_max3_f32 v250, v250, v89, v90
    v_mfma_f32_16x16x32_bf16 v[236:239], v[104:107], v[180:183], v[236:239]
    v_max3_f32 v250, v250, v251, v91
    v_add_u32 v13, 0xc0, v13
    v_mfma_f32_16x16x32_bf16 v[236:239], v[128:131], v[184:187], v[236:239]
    s_add_u32 s61, s61, s55
    v_mov_b32 v251, v250
    v_mul_f32 v191, v191, v155
    v_mfma_f32_16x16x32_bf16 v[224:227], v[132:135], v[184:187], v[224:227]
    v_permlane32_swap_b32 v250, v251
    v_mfma_f32_16x16x32_bf16 v[228:231], v[112:115], v[180:183], v[228:231]
    v_mul_f32 v189, v189, v153
    v_fma_f32 v70, v70, v241, v253
    v_mfma_f32_16x16x32_bf16 v[228:231], v[136:139], v[184:187], v[228:231]
    v_exp_f32 v73, v73
    v_cvt_pk_bf16_f32 v174, v192, v193
    v_cvt_pk_bf16_f32 v213, v238, v239
    v_max_f32 v250, v250, v251
    v_cvt_pk_bf16_f32 v175, v194, v195
    v_mfma_f32_16x16x32_bf16 v[232:235], v[140:143], v[184:187], v[232:235]
    v_cvt_pk_bf16_f32 v217, v230, v231
    v_cvt_pk_bf16_f32 v215, v226, v227
    v_cvt_pk_bf16_f32 v214, v224, v225
    v_exp_f32 v74, v74
    v_cvt_pk_bf16_f32 v216, v228, v229
    v_mov_b32 v251, v250
    s_sub_u32 s55, 0, s55
    v_cvt_pk_bf16_f32 v212, v236, v237
    s_waitcnt lgkmcnt(0)
    v_mfma_f32_4x4x4_16b_bf16 v[236:239], v[28:29], v[220:221], 0
    v_cvt_pk_bf16_f32 v219, v234, v235
    v_mfma_f32_4x4x4_16b_bf16 v[224:227], v[28:29], v[222:223], 0
    v_permlane16_swap_b32 v250, v251
    v_max_f32 v250, v250, v251
    v_mul_f32 v74, v74, v158
    v_mfma_f32_16x16x32_bf16 v[236:239], v[120:123], v[180:183], v[236:239]
    v_cvt_pk_bf16_f32 v172, v188, v189
    v_cvt_pk_bf16_f32 v218, v232, v233
    v_mfma_f32_16x16x32_bf16 v[236:239], v[144:147], v[184:187], v[236:239]
    v_fma_f32 v71, v71, v241, v253
    v_mul_f32_e64 v250, -v250, v242
    s_add_u32 s39, s39, 1
    v_fma_f32 v90, v90, v242, v250
    v_fma_f32 v89, v89, v242, v250
    v_mfma_f32_16x16x32_bf16 v[224:227], v[124:127], v[180:183], v[224:227]
    v_cvt_pk_bf16_f32 v173, v190, v191
    v_fma_f32 v82, v82, v242, v250
    v_mfma_f32_16x16x32_bf16 v[224:227], v[148:151], v[184:187], v[224:227]
    v_fma_f32 v87, v87, v242, v250
    v_fma_f32 v80, v80, v242, v250
    v_mfma_f32_16x16x32_bf16 v[232:235], v[104:107], v[172:175], 0
    v_cvt_pk_bf16_f32 v220, v236, v237
    v_cvt_pk_bf16_f32 v221, v238, v239
    v_mfma_f32_16x16x32_bf16 v[236:239], v[108:111], v[172:175], 0
    v_exp_f32 v76, v76
    v_mfma_f32_16x16x32_bf16 v[228:231], v[164:167], v[172:175], 0
    v_exp_f32 v87, v87
    v_mfma_f32_16x16x32_bf16 v[232:235], v[128:131], v[176:179], v[232:235]
    v_fma_f32 v83, v83, v242, v250
    v_exp_f32 v83, v83
    v_mfma_f32_16x16x32_bf16 v[228:231], v[168:171], v[176:179], v[228:231]
    v_exp_f32 v82, v82
    v_mfma_f32_16x16x32_bf16 v[236:239], v[132:135], v[176:179], v[236:239]
    v_fma_f32 v78, v78, v241, v253
    v_cvt_pk_bf16_f32 v223, v226, v227
    buffer_store_dwordx4 v[216:219], v23, s[8:11], s60 offen offset:64 sc0 sc1
    v_exp_f32 v78, v78
    v_fma_f32 v247, v247, v242, v250
    v_fma_f32 v84, v84, v242, v250
    v_rcp_f32 v255, v228
    v_mfma_f32_16x16x32_bf16 v[228:231], v[116:119], v[172:175], 0
    v_exp_f32 v77, v77
    v_mul_f32 v235, v235, v255
    v_cvt_pk_bf16_f32 v222, v224, v225
    v_mfma_f32_16x16x32_bf16 v[224:227], v[112:115], v[172:175], 0
    v_mul_f32 v236, v236, v255
    v_cvt_pk_bf16_f32 v183, v74, v75
    buffer_store_dwordx4 v[212:215], v23, s[8:11], s60 offen sc0 sc1
    v_fma_f32 v79, v79, v241, v253
    v_mul_f32 v234, v234, v255
    v_mfma_f32_16x16x32_bf16 v[224:227], v[136:139], v[176:179], v[224:227]
    v_mul_f32 v233, v233, v255
    v_mul_f32 v238, v238, v255
    v_mfma_f32_16x16x32_bf16 v[228:231], v[140:143], v[176:179], v[228:231]
    v_mul_f32 v73, v73, v157
    v_mul_f32 v232, v232, v255
    v_mul_f32 v239, v239, v255
    v_mul_f32 v237, v237, v255
    v_mul_f32 v83, v83, v155
    v_exp_f32 v70, v70
    v_mfma_f32_4x4x4_16b_bf16 v[236:239], v[28:29], v[34:35], v[236:239]
    v_fma_f32 v86, v86, v242, v250
    v_mfma_f32_4x4x4_16b_bf16 v[232:235], v[28:29], v[32:33], v[232:235]
    v_mul_f32 v229, v229, v255
    v_mul_f32 v227, v227, v255
    s_nop 0
    v_cvt_pk_bf16_f32 v95, v238, v239
    v_cvt_pk_bf16_f32 v94, v236, v237
    v_mfma_f32_16x16x32_bf16 v[236:239], v[124:127], v[172:175], 0
    v_mul_f32 v225, v225, v255
    v_mul_f32 v224, v224, v255
    v_mfma_f32_16x16x32_bf16 v[236:239], v[148:151], v[176:179], v[236:239]
    v_fma_f32 v85, v85, v242, v250
    v_mul_f32 v226, v226, v255
    buffer_store_dwordx4 v[220:223], v23, s[8:11], s60 offen offset:128 sc0 sc1
    v_fma_f32 v72, v72, v241, v253
    v_mul_f32 v230, v230, v255
    v_cvt_pk_bf16_f32 v93, v234, v235
    v_cvt_pk_bf16_f32 v92, v232, v233
    ds_write_b128 v21, v[92:95]
    v_exp_f32 v71, v71
    v_mfma_f32_16x16x32_bf16 v[232:235], v[120:123], v[172:175], 0
    v_fma_f32 v88, v88, v242, v250
    v_mul_f32 v228, v228, v255
    v_mfma_f32_16x16x32_bf16 v[232:235], v[144:147], v[176:179], v[232:235]
    v_mul_f32 v239, v239, v255
    v_mul_f32 v231, v231, v255
    v_mul_f32 v238, v238, v255
    v_exp_f32 v79, v79
    v_mfma_f32_4x4x4_16b_bf16 v[228:231], v[28:29], v[38:39], v[228:231]
    v_mul_f32 v236, v236, v255
    v_mfma_f32_4x4x4_16b_bf16 v[224:227], v[28:29], v[36:37], v[224:227]
    v_mul_f32 v232, v232, v255
    v_mul_f32 v237, v237, v255
    v_mul_f32 v234, v234, v255
    v_fma_f32 v91, v91, v242, v250
    v_cvt_pk_bf16_f32 v98, v228, v229
    v_exp_f32 v68, v68
    v_mfma_f32_4x4x4_16b_bf16 v[236:239], v[28:29], v[42:43], v[236:239]
    v_cvt_pk_bf16_f32 v97, v226, v227
    v_cvt_pk_bf16_f32 v99, v230, v231
    v_fma_f32 v81, v81, v242, v250
    v_cvt_pk_bf16_f32 v96, v224, v225
    v_fma_f32 v246, v246, v241, v253
    v_mul_f32 v78, v78, v162
    v_mul_f32 v233, v233, v255
    v_mul_f32 v235, v235, v255
    ds_write_b128 v21, v[96:99] offset:64
    v_exp_f32 v89, v89
    v_mfma_f32_4x4x4_16b_bf16 v[232:235], v[28:29], v[40:41], v[232:235]
    v_cvt_pk_bf16_f32 v102, v236, v237
    v_cvt_pk_bf16_f32 v103, v238, v239
    v_mul_f32 v82, v82, v154
    v_cvt_pk_bf16_f32 v173, v82, v83
    s_nop 0
    v_cvt_pk_bf16_f32 v100, v232, v233
    v_cvt_pk_bf16_f32 v101, v234, v235
    ds_write_b128 v21, v[100:103] offset:128
    v_exp_f32 v247, v247
    v_exp_f32 v69, v69
    v_add_u32 v12, v12, v25
    v_exp_f32 v72, v72
    ds_read_b128 v[92:95], v22
    ds_read_b128 v[96:99], v22 offset:1024
    ds_read_b128 v[100:103], v22 offset:2048
    v_mul_f32 v68, v68, v152
    v_exp_f32 v85, v85
    v_mul_f32 v69, v69, v153
    v_exp_f32 v81, v81
    v_mul_f32 v247, v247, v244
    v_exp_f32 v88, v88
    s_nop 0
    v_mul_f32 v88, v88, v160
    v_mul_f32 v87, v87, v159
    v_exp_f32 v86, v86
    v_mul_f32 v77, v77, v161
    v_exp_f32 v91, v91
    v_exp_f32 v90, v90
    v_cvt_pk_bf16_f32 v178, v247, 0
    v_mul_f32 v72, v72, v156
    s_waitcnt lgkmcnt(2)
    buffer_store_dwordx4 v[92:95], v1, s[8:11], s60 offen sc0 sc1
    v_mul_f32 v79, v79, v163
    v_mul_f32 v91, v91, v163
    v_exp_f32 v84, v84
    v_mul_f32 v90, v90, v162
    v_mul_f32 v76, v76, v160
    v_mul_f32 v85, v85, v157
    v_exp_f32 v246, v246
    v_cvt_pk_bf16_f32 v184, v76, v77
    v_exp_f32 v80, v80
    v_mul_f32 v246, v246, v244
    v_cvt_pk_bf16_f32 v186, v246, 0
    v_cvt_pk_bf16_f32 v177, v90, v91
    v_cvt_pk_bf16_f32 v185, v78, v79
    v_mul_f32 v86, v86, v158
    v_mul_f32 v80, v80, v152
    s_waitcnt lgkmcnt(1)
    buffer_store_dwordx4 v[96:99], v2, s[8:11], s60 offen sc0 sc1
    v_mul_f32 v84, v84, v156
    v_cvt_pk_bf16_f32 v174, v84, v85
    v_mul_f32 v89, v89, v161
    v_mul_f32 v70, v70, v154
    v_mul_f32 v71, v71, v155
    v_cvt_pk_bf16_f32 v181, v70, v71
    v_mul_f32 v81, v81, v153
    v_cvt_pk_bf16_f32 v182, v72, v73
    v_cvt_pk_bf16_f32 v175, v86, v87
    v_cvt_pk_bf16_f32 v172, v80, v81
    v_cvt_pk_bf16_f32 v176, v88, v89
    v_cvt_pk_bf16_f32 v180, v68, v69
    s_waitcnt lgkmcnt(0)
    buffer_store_dwordx4 v[100:103], v3, s[8:11], s60 offen sc0 sc1
    s_waitcnt vmcnt(6)
    s_waitcnt lgkmcnt(0)
    s_cmp_lt_u32 s39, s38
    s_cbranch_scc1 L_Sloop
    v_mfma_f32_16x16x32_bf16 v[224:227], v[164:167], v[180:183], 0
    v_mfma_f32_16x16x32_bf16 v[224:227], v[168:171], v[184:187], v[224:227]
    v_mfma_f32_16x16x32_bf16 v[228:231], v[104:107], v[180:183], 0
    v_mfma_f32_16x16x32_bf16 v[228:231], v[128:131], v[184:187], v[228:231]
    v_rcp_f32 v255, v224
    v_mfma_f32_16x16x32_bf16 v[232:235], v[108:111], v[180:183], 0
    v_mfma_f32_16x16x32_bf16 v[232:235], v[132:135], v[184:187], v[232:235]
    v_mul_f32 v228, v228, v255
    v_mul_f32 v229, v229, v255
    v_mfma_f32_16x16x32_bf16 v[236:239], v[112:115], v[180:183], 0
    v_mul_f32 v230, v230, v255
    v_mul_f32 v231, v231, v255
    v_mfma_f32_16x16x32_bf16 v[236:239], v[136:139], v[184:187], v[236:239]
    v_mul_f32 v232, v232, v255
    v_mul_f32 v233, v233, v255
    v_mfma_f32_16x16x32_bf16 v[224:227], v[116:119], v[180:183], 0
    v_mul_f32 v234, v234, v255
    v_mul_f32 v235, v235, v255
    v_mfma_f32_16x16x32_bf16 v[224:227], v[140:143], v[184:187], v[224:227]
    v_mul_f32 v236, v236, v255
    v_mul_f32 v237, v237, v255
    v_mul_f32 v238, v238, v255
    v_mfma_f32_4x4x4_16b_bf16 v[228:231], v[28:29], v[44:45], v[228:231]
    v_mul_f32 v239, v239, v255
    v_mfma_f32_4x4x4_16b_bf16 v[232:235], v[28:29], v[46:47], v[232:235]
    v_mfma_f32_4x4x4_16b_bf16 v[236:239], v[28:29], v[48:49], v[236:239]
    v_mul_f32 v224, v224, v255
    v_cvt_pk_bf16_f32 v68, v228, v229
    v_cvt_pk_bf16_f32 v69, v230, v231
    v_mfma_f32_16x16x32_bf16 v[228:231], v[120:123], v[180:183], 0
    v_cvt_pk_bf16_f32 v70, v232, v233
    v_cvt_pk_bf16_f32 v71, v234, v235
    v_mfma_f32_16x16x32_bf16 v[228:231], v[144:147], v[184:187], v[228:231]
    v_cvt_pk_bf16_f32 v72, v236, v237
    v_cvt_pk_bf16_f32 v73, v238, v239
    v_mfma_f32_16x16x32_bf16 v[232:235], v[124:127], v[180:183], 0
    v_mul_f32 v225, v225, v255
    v_mul_f32 v226, v226, v255
    v_mfma_f32_16x16x32_bf16 v[232:235], v[148:151], v[184:187], v[232:235]
    ds_write_b128 v21, v[68:71]
    v_mfma_f32_16x16x32_bf16 v[236:239], v[164:167], v[172:175], 0
    v_mul_f32 v227, v227, v255
    v_mul_f32 v228, v228, v255
    v_mfma_f32_16x16x32_bf16 v[236:239], v[168:171], v[176:179], v[236:239]
    v_mul_f32 v229, v229, v255
    v_mul_f32 v230, v230, v255
    v_mul_f32 v231, v231, v255
    v_mfma_f32_4x4x4_16b_bf16 v[224:227], v[28:29], v[50:51], v[224:227]
    v_mul_f32 v232, v232, v255
    v_mfma_f32_4x4x4_16b_bf16 v[228:231], v[28:29], v[52:53], v[228:231]
    v_mul_f32 v233, v233, v255
    v_mul_f32 v234, v234, v255
    v_mul_f32 v235, v235, v255
    v_cvt_pk_bf16_f32 v74, v224, v225
    v_cvt_pk_bf16_f32 v75, v226, v227
    v_mfma_f32_4x4x4_16b_bf16 v[232:235], v[28:29], v[54:55], v[232:235]
    v_cvt_pk_bf16_f32 v76, v228, v229
    v_cvt_pk_bf16_f32 v77, v230, v231
    v_mfma_f32_16x16x32_bf16 v[224:227], v[104:107], v[172:175], 0
    ds_write_b128 v21, v[72:75] offset:64
    v_mfma_f32_16x16x32_bf16 v[224:227], v[128:131], v[176:179], v[224:227]
    v_cvt_pk_bf16_f32 v78, v232, v233
    v_cvt_pk_bf16_f32 v79, v234, v235
    v_mfma_f32_16x16x32_bf16 v[228:231], v[108:111], v[172:175], 0
    v_rcp_f32 v252, v236
    v_mfma_f32_16x16x32_bf16 v[228:231], v[132:135], v[176:179], v[228:231]
    v_mul_f32 v224, v224, v252
    v_mul_f32 v225, v225, v252
    v_mfma_f32_16x16x32_bf16 v[232:235], v[112:115], v[172:175], 0
    v_mul_f32 v226, v226, v252
    v_mul_f32 v227, v227, v252
    v_mfma_f32_16x16x32_bf16 v[232:235], v[136:139], v[176:179], v[232:235]
    v_mul_f32 v228, v228, v252
    v_mul_f32 v229, v229, v252
    v_mfma_f32_16x16x32_bf16 v[236:239], v[116:119], v[172:175], 0
    ds_write_b128 v21, v[76:79] offset:128
    v_mfma_f32_4x4x4_16b_bf16 v[224:227], v[28:29], v[56:57], v[224:227]
    ds_read_b128 v[68:71], v22
    ds_read_b128 v[72:75], v22 offset:1024
    ds_read_b128 v[76:79], v22 offset:2048
    v_mfma_f32_16x16x32_bf16 v[236:239], v[140:143], v[176:179], v[236:239]
    v_cvt_pk_bf16_f32 v80, v224, v225
    v_cvt_pk_bf16_f32 v81, v226, v227
    v_mul_f32 v230, v230, v252
    v_mul_f32 v231, v231, v252
    v_mul_f32 v232, v232, v252
    v_mul_f32 v233, v233, v252
    v_mfma_f32_4x4x4_16b_bf16 v[228:231], v[28:29], v[58:59], v[228:231]
    v_mul_f32 v234, v234, v252
    v_mul_f32 v235, v235, v252
    s_nop 1
    v_mfma_f32_4x4x4_16b_bf16 v[232:235], v[28:29], v[60:61], v[232:235]
    v_cvt_pk_bf16_f32 v82, v228, v229
    v_cvt_pk_bf16_f32 v83, v230, v231
    ds_write_b128 v21, v[80:83]
    s_nop 1
    v_cvt_pk_bf16_f32 v84, v232, v233
    v_cvt_pk_bf16_f32 v85, v234, v235
    s_waitcnt lgkmcnt(3)
    buffer_store_dwordx4 v[68:71], v4, s[8:11], s60 offen sc0 sc1
    s_waitcnt lgkmcnt(2)
    buffer_store_dwordx4 v[72:75], v5, s[8:11], s60 offen sc0 sc1
    s_waitcnt lgkmcnt(1)
    buffer_store_dwordx4 v[76:79], v6, s[8:11], s60 offen sc0 sc1
    v_mfma_f32_16x16x32_bf16 v[224:227], v[120:123], v[172:175], 0
    v_mul_f32 v236, v236, v252
    v_mul_f32 v237, v237, v252
    v_mfma_f32_16x16x32_bf16 v[224:227], v[144:147], v[176:179], v[224:227]
    v_mul_f32 v238, v238, v252
    v_mul_f32 v239, v239, v252
    v_mfma_f32_16x16x32_bf16 v[228:231], v[124:127], v[172:175], 0
    v_mfma_f32_16x16x32_bf16 v[228:231], v[148:151], v[176:179], v[228:231]
    v_mul_f32 v224, v224, v252
    v_mul_f32 v225, v225, v252
    v_mul_f32 v226, v226, v252
    v_mfma_f32_4x4x4_16b_bf16 v[236:239], v[28:29], v[62:63], v[236:239]
    v_mul_f32 v227, v227, v252
    s_nop 1
    v_mfma_f32_4x4x4_16b_bf16 v[224:227], v[28:29], v[64:65], v[224:227]
    v_mul_f32 v228, v228, v252
    v_cvt_pk_bf16_f32 v86, v236, v237
    v_cvt_pk_bf16_f32 v87, v238, v239
    v_mul_f32 v229, v229, v252
    v_mul_f32 v230, v230, v252
    v_cvt_pk_bf16_f32 v88, v224, v225
    v_cvt_pk_bf16_f32 v89, v226, v227
    v_mul_f32 v231, v231, v252
    s_nop 1
    v_mfma_f32_4x4x4_16b_bf16 v[228:231], v[28:29], v[66:67], v[228:231]
    ds_write_b128 v21, v[84:87] offset:64
    s_nop 3
    v_cvt_pk_bf16_f32 v90, v228, v229
    v_cvt_pk_bf16_f32 v91, v230, v231
    ds_write_b128 v21, v[88:91] offset:128
    ds_read_b128 v[80:83], v22
    ds_read_b128 v[84:87], v22 offset:1024
    ds_read_b128 v[88:91], v22 offset:2048
    s_waitcnt lgkmcnt(2)
    buffer_store_dwordx4 v[80:83], v7, s[8:11], s60 offen sc0 sc1
    s_waitcnt lgkmcnt(1)
    buffer_store_dwordx4 v[84:87], v8, s[8:11], s60 offen sc0 sc1
    s_waitcnt lgkmcnt(0)
    buffer_store_dwordx4 v[88:91], v9, s[8:11], s60 offen sc0 sc1
    s_nop 1
L_end:
    s_endpgm
.section .rodata,"a"
.p2align 6
.amdhsa_kernel standalone__video_video_swin__vision_kernel
  .amdhsa_next_free_vgpr 256
  .amdhsa_next_free_sgpr 102
  .amdhsa_accum_offset 256
  .amdhsa_group_segment_fixed_size 0
  .amdhsa_kernarg_size 64
  .amdhsa_user_sgpr_count 2
  .amdhsa_user_sgpr_kernarg_segment_ptr 1
  .amdhsa_system_sgpr_workgroup_id_x 1
  .amdhsa_float_denorm_mode_32 3
.end_amdhsa_kernel
```
